```python
import torch

def _softmax(x, axis=-1):
    return torch.softmax(x, dim=axis)
def _gelu(x):
    return torch.nn.functional.gelu(x, approximate="tanh")
def _silu(x):
    return torch.nn.functional.silu(x)
def _sigmoid(x):
    return torch.sigmoid(x)
def _layernorm(x, axis=-1, eps=1e-5):
    m = x.mean(dim=axis, keepdim=True)
    v = x.var(dim=axis, keepdim=True, unbiased=False)
    return (x - m) / torch.sqrt(v + eps)
def _scatter_add(tgt, idx, src, axis=0):
    return tgt.clone().index_add_(axis, idx, src)
def _segment_sum(src, seg, n):
    out = torch.zeros((n,) + src.shape[1:], dtype=src.dtype)
    return out.index_add_(0, seg, src)
def _pad(x, pw):
    flat = tuple(v for pair in reversed(pw) for v in pair)
    return torch.nn.functional.pad(x, flat)

kernel_name = 'gated_mix__linear_attn_block__dense_activation_mish__prompt'

def setup_inputs():

    _w = (lambda a: (lambda t: t.to(torch.bfloat16) if t.is_floating_point() else t)(torch.as_tensor(a)))
    def _A_setup():
        B, S, D = 1, 2048, 448
        return {
            "x": _w((lambda *s: torch.randn(*s, dtype=torch.bfloat16) * 0.05)(B, S, D)),
            "wqkv": _w((lambda *s: torch.randn(*s, dtype=torch.bfloat16) * 0.8)(D, 3 * D)),
            "wo": _w((lambda *s: torch.randn(*s, dtype=torch.bfloat16) * 0.1)(D, D)),
        }
    _A_in = _A_setup()

    def _B_setup():
        B, S, D, F = 1, 2048, 448, 1792
        return {
            "x": _w((lambda *s: torch.randn(*s, dtype=torch.bfloat16) * 0.05)(B, S, D)),
            "w1": _w((lambda *s: torch.randn(*s, dtype=torch.bfloat16) * 12.8)(D, F) * (D ** -0.5)),
            "b1": _w((lambda *s: torch.randn(*s, dtype=torch.bfloat16) * 0.2)(F)),
            "w2": _w((lambda *s: torch.randn(*s, dtype=torch.bfloat16) * 0.05)(F, D) * (F ** -0.5)),
        }
    _B_in = _B_setup()

    return {
        "A_x": _A_in["x"],
        "A_wqkv": _A_in["wqkv"],
        "A_wo": _A_in["wo"],
        "B_x": _B_in["x"],
        "B_w1": _B_in["w1"],
        "B_b1": _B_in["b1"],
        "B_w2": _B_in["w2"],
        "gate_w": _w((lambda *s: torch.randn(*s, dtype=torch.bfloat16) * 0.05)(448) * 16.0),
    }

def reference(A_x, A_wqkv, A_wo, B_x, B_w1, B_b1, B_w2, gate_w):
    def _A_ref(x, wqkv, wo):
        B, S, D = x.shape
        H = 16; Dh = D // H
        qkv = (lambda x, *d: x.permute(*d))((x @ wqkv).reshape(B, S, 3, H, Dh), 2, 0, 3, 1, 4)
        q, k, v = qkv[0], qkv[1], qkv[2]
        phi = lambda t: torch.where(t > 0, t + 1, torch.exp(t)) + 1e-6
        pq, pk = phi(q), phi(k)
        kv = torch.einsum("bhsd,bhse->bhde", pk, v)
        z = torch.einsum("bhsd->bhd", pk)
        num = torch.einsum("bhqd,bhde->bhqe", pq, kv)
        den = torch.einsum("bhqd,bhd->bhq", pq, z)[..., None] + 1e-6
        o = num / den
        return (lambda x, *d: x.permute(*d))(o, 0, 2, 1, 3).reshape(B, S, D) @ wo

    def _B_ref(x, w1, b1, w2):
        h = torch.einsum("bsd,df->bsf", x, w1) + b1
        sp = torch.log1p(torch.exp(-torch.abs(h))) + torch.where(h > 0, h, torch.zeros_like(h))
        act = h * torch.tanh(sp)
        return torch.einsum("bsf,fd->bsd", act, w2)

    x = A_x
    g = _sigmoid((x * gate_w).sum(-1, keepdims=True))
    a = _A_ref(x, A_wqkv, A_wo)
    b = _B_ref(x, B_w1, B_b1, B_w2)
    return g * a + (1 - g) * b
```

```asm
; @launch grid=(256,1,1) block=(512,1,1) lds=163840
.amdgcn_target "amdgcn-amd-amdhsa--gfx950"
.text
.globl gated_mix__linear_attn_block__dense_activation_mish__prompt_kernel
.p2align 8
.type gated_mix__linear_attn_block__dense_activation_mish__prompt_kernel,@function
gated_mix__linear_attn_block__dense_activation_mish__prompt_kernel:
  s_cmp_ge_u32 s2, 256
  s_cbranch_scc1 L_end
  s_load_dwordx16 s[4:19], s[0:1], 0
  s_memrealtime s[60:61]
  v_lshrrev_b32 v96, 6, v0
  v_and_b32 v1, 63, v0
  v_readfirstlane_b32 s52, v96
  v_mov_b32 v22, 0
  s_lshr_b32 s62, s2, 3
  s_and_b32 s63, s2, 1
  s_lshl_b32 s63, s63, 3
  s_and_b32 s64, s62, 7
  s_add_u32 s53, s63, s64
  s_lshr_b32 s65, s62, 3
  s_and_b32 s63, s2, 6
  s_and_b32 s66, s65, 1
  s_lshl_b32 s67, s65, 1
  s_add_u32 s55, s64, s67
  s_cmp_ge_u32 s55, 7
  s_cselect_b32 s67, 7, 0
  s_sub_u32 s55, s55, s67
  s_xor_b32 s55, s64, s65
  s_and_b32 s55, s55, 1
  s_mul_i32 s55, s55, 3
  s_and_b32 s67, s2, 7
  s_add_u32 s55, s55, s67
  s_cmp_ge_u32 s55, 7
  s_cselect_b32 s67, 7, 0
  s_sub_u32 s55, s55, s67
  v_lshrrev_b32 v96, 3, v1
  v_and_b32 v97, 7, v1
  v_lshrrev_b32 v98, 4, v1
  v_lshl_add_u32 v99, s52, 4, v96
  v_mul_u32_u24 v99, 896, v99
  v_xor_b32 v100, v97, v98
  v_lshl_add_u32 v2, v100, 4, v99
  v_xor_b32 v100, 4, v100
  v_lshl_add_u32 v3, v100, 4, v99
  v_add_u32 v3, 6144, v3
  v_and_b32 v101, 1, v98
  v_lshlrev_b32 v101, 2, v101
  v_xor_b32 v101, v101, v97
  s_cmp_ge_u32 s65, 2
  s_cbranch_scc1 L_att
  s_add_u32 s54, s63, s66
  s_add_u32 s58, s54, 8
  s_mul_i32 s62, s53, 114688
  s_lshl_b32 s63, s55, 7
  s_add_u32 s62, s62, s63
  s_sub_u32 s63, s62, 896
  s_mul_i32 s64, s55, 229376
  s_mul_i32 s65, s54, 448
  s_add_u32 s64, s64, s65
  s_sub_u32 s65, s64, 1605632
  s_cmp_ge_u32 s55, 7
  s_cselect_b32 s68, s63, s62
  s_cselect_b32 s75, s65, s64
  s_cmp_ge_u32 s55, 6
  s_cselect_b32 s69, s63, s62
  s_cselect_b32 s76, s65, s64
  s_add_u32 s69, s69, 128
  s_add_u32 s76, s76, 229376
  s_cmp_ge_u32 s55, 5
  s_cselect_b32 s70, s63, s62
  s_cselect_b32 s77, s65, s64
  s_add_u32 s70, s70, 256
  s_add_u32 s77, s77, 458752
  s_cmp_ge_u32 s55, 4
  s_cselect_b32 s71, s63, s62
  s_cselect_b32 s78, s65, s64
  s_add_u32 s71, s71, 384
  s_add_u32 s78, s78, 688128
  s_cmp_ge_u32 s55, 3
  s_cselect_b32 s72, s63, s62
  s_cselect_b32 s79, s65, s64
  s_add_u32 s72, s72, 512
  s_add_u32 s79, s79, 917504
  s_cmp_ge_u32 s55, 2
  s_cselect_b32 s73, s63, s62
  s_cselect_b32 s80, s65, s64
  s_add_u32 s73, s73, 640
  s_add_u32 s80, s80, 1146880
  s_cmp_ge_u32 s55, 1
  s_cselect_b32 s74, s63, s62
  s_cselect_b32 s81, s65, s64
  s_add_u32 s74, s74, 768
  s_add_u32 s81, s81, 1376256
  v_lshl_add_u32 v99, s52, 3, v96
  v_mul_u32_u24 v99, 3584, v99
  s_and_b32 s67, s54, 1
  s_lshl_b32 s66, s67, 6
  v_lshl_add_u32 v4, v101, 4, v99
  v_add_u32 v4, s66, v4
  s_cmp_eq_u32 s67, 0
  s_cselect_b32 s67, 384, 0
  s_and_b32 s66, s52, 3
  s_mul_i32 s66, s66, 57344
  s_add_u32 s66, s66, s67
  v_lshrrev_b32 v99, 2, v1
  v_mul_u32_u24 v99, 3584, v99
  v_and_b32 v100, 3, v1
  v_lshl_add_u32 v5, v100, 4, v99
  v_add_u32 v5, s66, v5
  s_waitcnt lgkmcnt(0)
  s_load_dwordx4 s[20:23], s[0:1], 64
  s_load_dwordx2 s[24:25], s[0:1], 80
  s_lshl_b32 s10, s52, 10
  s_lshl_b32 s11, s52, 11
  s_mov_b32 s28, s4
  s_mov_b32 s29, s5
  s_mov_b32 s30, 1835008
  s_mov_b32 s31, 0x20000
  s_mov_b32 s32, s12
  s_mov_b32 s33, s13
  s_mov_b32 s34, 1605632
  s_mov_b32 s35, 0x20000
  s_add_u32 m0, s11, 65536
  s_nop 0
  buffer_load_dwordx4 v2, s[28:31], s68 offen lds
  s_add_u32 m0, s11, 65536
  s_nop 0
  buffer_load_dwordx4 v3, s[28:31], s68 offen offset:1024 lds
  s_add_u32 m0, s10, 81920
  s_nop 0
  buffer_load_dwordx4 v4, s[32:35], s75 offen lds
  s_add_u32 m0, s10, 89984
  s_nop 0
  buffer_load_dwordx4 v4, s[32:35], s75 offen offset:128 lds
  s_barrier
  s_and_b32 s59, s52, 3
  s_lshr_b32 s93, s52, 2
  v_and_b32 v102, 31, v1
  v_lshrrev_b32 v103, 5, v1
  v_bfe_u32 v104, v1, 1, 3
  v_xor_b32 v104, v104, v103
  v_lshlrev_b32 v104, 4, v104
  v_lshl_add_u32 v104, v102, 7, v104
  s_lshl_b32 s66, s59, 12
  s_add_u32 s66, s66, 65536
  s_mul_i32 s62, s93, 8
  v_xor_b32 v6, 0, v104
  v_add_u32 v6, s66, v6
  v_xor_b32 v7, 32, v104
  v_add_u32 v7, s66, v7
  v_xor_b32 v8, 64, v104
  v_add_u32 v8, s66, v8
  v_xor_b32 v9, 96, v104
  v_add_u32 v9, s66, v9
  v_bfe_u32 v105, v1, 2, 2
  v_and_b32 v106, 3, v1
  v_bfe_u32 v107, v1, 4, 1
  v_lshl_add_u32 v108, v107, 2, v106
  v_lshl_add_u32 v109, v103, 3, v105
  v_add_u32 v110, s62, v108
  v_lshrrev_b32 v97, 1, v110
  v_and_b32 v98, 2, v105
  v_lshlrev_b32 v98, 1, v98
  v_xor_b32 v97, v97, v98
  v_and_b32 v110, 1, v110
  v_lshlrev_b32 v110, 3, v110
  v_lshl_add_u32 v110, v97, 4, v110
  v_lshl_add_u32 v11, v109, 7, v110
  s_lshl_b32 s62, s93, 6
  s_lshl_b32 s63, s93, 13
  s_add_u32 s63, s63, 81920
  v_xor_b32 v10, s62, v11
  v_add_u32 v10, s63, v10
  v_xor_b32 v0, 64, v10
  v_lshlrev_b32 v110, 2, v1
  ds_write_b32 v110, v22 offset:57344
  s_add_u32 m0, s11, 131072
  s_nop 0
  buffer_load_dwordx4 v2, s[28:31], s69 offen lds
  s_add_u32 m0, s11, 131072
  s_nop 0
  buffer_load_dwordx4 v3, s[28:31], s69 offen offset:1024 lds
  s_add_u32 m0, s10, 147456
  s_nop 0
  buffer_load_dwordx4 v4, s[32:35], s76 offen lds
  s_add_u32 m0, s10, 155520
  s_nop 0
  buffer_load_dwordx4 v4, s[32:35], s76 offen offset:128 lds
  s_mul_i32 s66, s54, 7
  s_and_b32 s67, s54, 1
  s_add_u32 s100, s66, s67
  s_add_u32 s100, s100, s93
  s_add_u32 s97, s100, 4
  s_add_u32 s100, s100, s93
  s_cmp_eq_u32 s67, 0
  s_cselect_b32 s67, 6, 0
  s_add_u32 s101, s66, s67
  s_mov_b32 s48, s14
  s_mov_b32 s49, s15
  s_mov_b32 s50, 3584
  s_mov_b32 s51, 0x20000
  v_lshlrev_b32 v111, 1, v102
  v_lshl_add_u32 v111, v103, 12, v111
  s_lshl_b32 s62, s100, 6
  s_lshl_b32 s63, s101, 6
  s_lshl_b32 s64, s97, 6
  buffer_load_ushort v24, v111, s[48:51], s62 offen offset:0
  buffer_load_ushort v25, v111, s[48:51], s62 offen offset:64
  buffer_load_ushort v14, v111, s[48:51], s64 offen offset:0
  buffer_load_ushort v15, v111, s[48:51], s63 offen offset:0
  s_waitcnt vmcnt(8) lgkmcnt(0)
  s_barrier
  ds_read_b128 a[0:3], v6
  ds_read_b128 a[4:7], v7
  ds_read_b128 a[8:11], v8
  ds_read_b128 a[12:15], v9
  ds_read_b64_tr_b16 v[64:65], v10 offset:0
  ds_read_b64_tr_b16 v[66:67], v10 offset:512
  ds_read_b64_tr_b16 v[68:69], v10 offset:2048
  ds_read_b64_tr_b16 v[70:71], v10 offset:2560
  ds_read_b64_tr_b16 v[72:73], v10 offset:4096
  ds_read_b64_tr_b16 v[74:75], v10 offset:4608
  ds_read_b64_tr_b16 v[76:77], v10 offset:6144
  ds_read_b64_tr_b16 v[78:79], v10 offset:6656
  s_waitcnt lgkmcnt(6)
  v_mfma_f32_32x32x16_bf16 v[32:47], v[64:67], a[0:3], 0
  ds_read_b64_tr_b16 v[80:81], v0 offset:0
  ds_read_b64_tr_b16 v[82:83], v0 offset:512
  s_add_u32 m0, s11, 98304
  s_nop 0
  buffer_load_dwordx4 v2, s[28:31], s70 offen lds
  s_or_b32 s66, s2, s52
  s_cmp_lg_u32 s66, 0
  s_cbranch_scc1 L_skip_1
  s_lshl_b64 s[60:61], s[60:61], 2
  s_or_b32 s61, s61, 0x40000000
  v_mov_b32 v120, s60
  v_mov_b32 v121, s61
  s_mov_b64 exec, 1
  global_store_dwordx2 v22, v[120:121], s[22:23] sc0 sc1
  s_mov_b64 exec, -1
L_skip_1:
  s_add_u32 m0, s11, 98304
  s_nop 0
  buffer_load_dwordx4 v3, s[28:31], s70 offen offset:1024 lds
  s_waitcnt lgkmcnt(6)
  v_mfma_f32_32x32x16_bf16 v[32:47], v[68:71], a[4:7], v[32:47]
  ds_read_b64_tr_b16 v[84:85], v0 offset:2048
  ds_read_b64_tr_b16 v[86:87], v0 offset:2560
  v_mov_b32 v112, 0x3f80
  v_mov_b32 v113, 0
  v_mov_b32 v114, 0
  v_mov_b32 v115, 0
  v_mov_b32 v116, 0
  v_mov_b32 v117, 0
  v_mov_b32 v118, 0
  v_mov_b32 v119, 0
  s_add_u32 m0, s10, 114688
  s_nop 0
  buffer_load_dwordx4 v4, s[32:35], s77 offen lds
  s_waitcnt lgkmcnt(6)
  v_mfma_f32_32x32x16_bf16 v[32:47], v[72:75], a[8:11], v[32:47]
  ds_read_b64_tr_b16 v[88:89], v0 offset:4096
  ds_read_b64_tr_b16 v[90:91], v0 offset:4608
  s_mov_b32 s44, s24
  s_mov_b32 s45, s25
  s_mov_b32 s46, 17825792
  s_mov_b32 s47, 0x20000
  v_lshlrev_b32 v12, 4, v1
  s_lshl_b32 s66, s53, 2
  s_add_u32 s66, s66, s59
  s_mul_i32 s82, s66, 147456
  s_add_u32 m0, s10, 122752
  s_nop 0
  buffer_load_dwordx4 v4, s[32:35], s77 offen offset:128 lds
  s_waitcnt lgkmcnt(6)
  v_mfma_f32_32x32x16_bf16 v[32:47], v[76:79], a[12:15], v[32:47]
  ds_read_b64_tr_b16 v[92:93], v0 offset:6144
  ds_read_b64_tr_b16 v[94:95], v0 offset:6656
  s_lshl_b32 s100, s100, 11
  s_add_u32 s100, s100, s82
  s_lshl_b32 s101, s101, 11
  s_add_u32 s101, s101, s82
  s_lshl_b32 s97, s97, 11
  s_add_u32 s97, s97, s82
  s_and_b32 s62, s53, 7
  s_lshl_b32 s62, s62, 1
  s_and_b32 s63, s54, 1
  s_add_u32 s62, s62, s63
  s_lshl_b32 s62, s62, 3
  s_add_u32 s62, s62, s52
  s_mul_i32 s62, s62, 14336
  s_lshr_b32 s63, s54, 1
  s_mul_i32 s63, s63, 896
  s_add_u32 s62, s62, s63
  v_mul_u32_u24 v111, 3584, v1
  s_mov_b64 exec, 15
  buffer_load_dword v16, v111, s[32:35], s62 offen offset:384
  s_mov_b64 exec, -1
  s_waitcnt lgkmcnt(6)
  v_mfma_f32_32x32x16_bf16 v[48:63], v[80:83], a[0:3], 0
  s_waitcnt vmcnt(9) lgkmcnt(0)
  s_barrier
  v_add_u32 v6, 0x10000, v6
  v_add_u32 v7, 0x10000, v7
  v_add_u32 v8, 0x10000, v8
  v_add_u32 v9, 0x10000, v9
  v_add_u32 v10, 0x10000, v10
  v_add_u32 v0, 0x10000, v0
  ds_read_b128 a[16:19], v6
  ds_read_b128 a[20:23], v7
  ds_read_b128 a[24:27], v8
  ds_read_b128 a[28:31], v9
  ds_read_b64_tr_b16 v[64:65], v10 offset:0
  ds_read_b64_tr_b16 v[66:67], v10 offset:512
  s_add_u32 m0, s11, 65536
  s_nop 0
  buffer_load_dwordx4 v2, s[28:31], s71 offen lds
  v_mfma_f32_32x32x16_bf16 v[48:63], v[84:87], a[4:7], v[48:63]
  ds_read_b64_tr_b16 v[68:69], v10 offset:2048
  ds_read_b64_tr_b16 v[70:71], v10 offset:2560
  s_lshr_b32 s65, s2, 3
  s_mul_i32 s66, s65, 37
  s_lshr_b32 s66, s66, 8
  s_mul_i32 s67, s66, 7
  s_sub_u32 s57, s65, s67
  s_and_b32 s62, s2, 7
  s_lshl_b32 s56, s62, 2
  s_add_u32 s56, s56, s66
  s_add_u32 s85, s57, s66
  s_lshl_b32 s85, s85, 1
  s_and_b32 s85, s2, 7
  s_lshl_b32 s85, s85, 1
  v_mfma_f32_32x32x16_bf16 v[48:63], v[88:91], a[8:11], v[48:63]
  ds_read_b64_tr_b16 v[72:73], v10 offset:4096
  ds_read_b64_tr_b16 v[74:75], v10 offset:4608
  s_add_u32 m0, s11, 65536
  s_nop 0
  buffer_load_dwordx4 v3, s[28:31], s71 offen offset:1024 lds
  v_mfma_f32_32x32x16_bf16 v[48:63], v[92:95], a[12:15], v[48:63]
  ds_read_b64_tr_b16 v[76:77], v10 offset:6144
  ds_read_b64_tr_b16 v[78:79], v10 offset:6656
  s_waitcnt lgkmcnt(6)
  v_mfma_f32_32x32x16_bf16 v[32:47], v[64:67], a[16:19], v[32:47]
  ds_read_b64_tr_b16 v[80:81], v0 offset:0
  ds_read_b64_tr_b16 v[82:83], v0 offset:512
  s_lshr_b32 s63, s56, 1
  s_mul_i32 s88, s52, 7168
  s_lshl_b32 s62, s57, 7
  s_add_u32 s88, s88, s62
  s_lshl_b32 s83, s63, 9
  s_add_u32 s83, s83, 16852992
  s_lshl_b32 s89, s54, 8
  s_add_u32 s89, s89, 16850944
  s_waitcnt lgkmcnt(6)
  v_mfma_f32_32x32x16_bf16 v[32:47], v[68:71], a[20:23], v[32:47]
  ds_read_b64_tr_b16 v[84:85], v0 offset:2048
  ds_read_b64_tr_b16 v[86:87], v0 offset:2560
  s_add_u32 m0, s10, 81920
  s_nop 0
  buffer_load_dwordx4 v4, s[32:35], s78 offen lds
  s_waitcnt lgkmcnt(6)
  v_mfma_f32_32x32x16_bf16 v[32:47], v[72:75], a[24:27], v[32:47]
  ds_read_b64_tr_b16 v[88:89], v0 offset:4096
  ds_read_b64_tr_b16 v[90:91], v0 offset:4608
  s_add_u32 m0, s10, 89984
  s_nop 0
  buffer_load_dwordx4 v4, s[32:35], s78 offen offset:128 lds
  s_waitcnt lgkmcnt(6)
  v_mfma_f32_32x32x16_bf16 v[32:47], v[76:79], a[28:31], v[32:47]
  ds_read_b64_tr_b16 v[92:93], v0 offset:6144
  ds_read_b64_tr_b16 v[94:95], v0 offset:6656
  s_waitcnt lgkmcnt(6)
  v_mfma_f32_32x32x16_bf16 v[48:63], v[80:83], a[16:19], v[48:63]
  s_waitcnt vmcnt(5) lgkmcnt(0)
  s_barrier
  v_add_u32 v6, 0xffff8000, v6
  v_add_u32 v7, 0xffff8000, v7
  v_add_u32 v8, 0xffff8000, v8
  v_add_u32 v9, 0xffff8000, v9
  v_add_u32 v10, 0xffff8000, v10
  v_add_u32 v0, 0xffff8000, v0
  ds_read_b128 a[32:35], v6
  ds_read_b128 a[36:39], v7
  ds_read_b128 a[40:43], v8
  ds_read_b128 a[44:47], v9
  ds_read_b64_tr_b16 v[64:65], v10 offset:0
  ds_read_b64_tr_b16 v[66:67], v10 offset:512
  s_add_u32 m0, s11, 131072
  s_nop 0
  buffer_load_dwordx4 v2, s[28:31], s72 offen lds
  v_mfma_f32_32x32x16_bf16 v[48:63], v[84:87], a[20:23], v[48:63]
  ds_read_b64_tr_b16 v[68:69], v10 offset:2048
  ds_read_b64_tr_b16 v[70:71], v10 offset:2560
  global_load_dwordx2 v[16:17], v22, s[22:23] sc1
  v_mfma_f32_32x32x16_bf16 v[48:63], v[88:91], a[24:27], v[48:63]
  ds_read_b64_tr_b16 v[72:73], v10 offset:4096
  ds_read_b64_tr_b16 v[74:75], v10 offset:4608
  s_add_u32 m0, s11, 131072
  s_nop 0
  buffer_load_dwordx4 v3, s[28:31], s72 offen offset:1024 lds
  v_mfma_f32_32x32x16_bf16 v[48:63], v[92:95], a[28:31], v[48:63]
  ds_read_b64_tr_b16 v[76:77], v10 offset:6144
  ds_read_b64_tr_b16 v[78:79], v10 offset:6656
  s_mov_b32 s36, s16
  s_mov_b32 s37, s17
  s_mov_b32 s38, 1605632
  s_mov_b32 s39, 0x20000
  s_mov_b32 s40, s8
  s_mov_b32 s41, s9
  s_mov_b32 s42, 401408
  s_mov_b32 s43, 0x20000
  v_mov_b32 v116, v24
  s_nop 1
  v_mfma_f32_32x32x16_bf16 v[32:47], v[116:119], v[112:115], v[32:47]
  s_waitcnt lgkmcnt(6)
  v_mfma_f32_32x32x16_bf16 v[32:47], v[64:67], a[32:35], v[32:47]
  ds_read_b64_tr_b16 v[80:81], v0 offset:0
  ds_read_b64_tr_b16 v[82:83], v0 offset:512
  s_add_u32 m0, s10, 147456
  s_nop 0
  buffer_load_dwordx4 v4, s[32:35], s79 offen lds
  s_waitcnt lgkmcnt(6)
  v_mfma_f32_32x32x16_bf16 v[32:47], v[68:71], a[36:39], v[32:47]
  ds_read_b64_tr_b16 v[84:85], v0 offset:2048
  ds_read_b64_tr_b16 v[86:87], v0 offset:2560
  s_mov_b32 s26, 0x3fb8aa3b
  s_mov_b32 s27, 0x3fb8aa3b
  s_mov_b32 s86, 0x358637bd
  s_mov_b32 s87, 0x358637bd
  v_and_b32 v13, 15, v1
  v_lshlrev_b32 v13, 3, v13
  v_lshlrev_b32 v31, 6, v109
  v_lshl_add_u32 v31, v108, 3, v31
  v_add_u32 v31, 98304, v31
  s_waitcnt lgkmcnt(6)
  v_mfma_f32_32x32x16_bf16 v[32:47], v[72:75], a[40:43], v[32:47]
  ds_read_b64_tr_b16 v[88:89], v0 offset:4096
  ds_read_b64_tr_b16 v[90:91], v0 offset:4608
  s_add_u32 m0, s10, 155520
  s_nop 0
  buffer_load_dwordx4 v4, s[32:35], s79 offen offset:128 lds
  s_waitcnt lgkmcnt(6)
  v_mfma_f32_32x32x16_bf16 v[32:47], v[76:79], a[44:47], v[32:47]
  ds_read_b64_tr_b16 v[92:93], v0 offset:6144
  ds_read_b64_tr_b16 v[94:95], v0 offset:6656
  v_mov_b32 v116, v25
  s_nop 1
  v_mfma_f32_32x32x16_bf16 v[48:63], v[116:119], v[112:115], v[48:63]
  s_waitcnt lgkmcnt(6)
  v_mfma_f32_32x32x16_bf16 v[48:63], v[80:83], a[32:35], v[48:63]
  s_waitcnt vmcnt(5) lgkmcnt(0)
  s_barrier
  v_add_u32 v6, 0xffff8000, v6
  v_add_u32 v7, 0xffff8000, v7
  v_add_u32 v8, 0xffff8000, v8
  v_add_u32 v9, 0xffff8000, v9
  v_add_u32 v10, 0xffff8000, v10
  v_add_u32 v0, 0xffff8000, v0
  ds_read_b128 a[48:51], v6
  ds_read_b128 a[52:55], v7
  ds_read_b128 a[56:59], v8
  ds_read_b128 a[60:63], v9
  ds_read_b64_tr_b16 v[64:65], v10 offset:0
  ds_read_b64_tr_b16 v[66:67], v10 offset:512
  s_add_u32 m0, s11, 98304
  s_nop 0
  buffer_load_dwordx4 v2, s[28:31], s73 offen lds
  v_mfma_f32_32x32x16_bf16 v[48:63], v[84:87], a[36:39], v[48:63]
  ds_read_b64_tr_b16 v[68:69], v10 offset:2048
  ds_read_b64_tr_b16 v[70:71], v10 offset:2560
  v_lshl_add_u32 v100, v103, 2, v105
  s_and_b32 s62, s52, 1
  s_lshl_b32 s63, s62, 3
  v_add_u32 v110, s63, v108
  v_lshrrev_b32 v97, 1, v110
  v_and_b32 v98, 2, v105
  v_lshlrev_b32 v98, 1, v98
  v_xor_b32 v97, v97, v98
  v_and_b32 v110, 1, v110
  v_lshlrev_b32 v110, 3, v110
  v_lshl_add_u32 v110, v97, 4, v110
  v_lshl_add_u32 v27, v100, 7, v110
  v_add_u32 v28, 114688, v27
  v_add_u32 v27, 65536, v27
  v_mfma_f32_32x32x16_bf16 v[48:63], v[88:91], a[40:43], v[48:63]
  ds_read_b64_tr_b16 v[72:73], v10 offset:4096
  ds_read_b64_tr_b16 v[74:75], v10 offset:4608
  s_add_u32 m0, s11, 98304
  s_nop 0
  buffer_load_dwordx4 v3, s[28:31], s73 offen offset:1024 lds
  v_mfma_f32_32x32x16_bf16 v[48:63], v[92:95], a[44:47], v[48:63]
  ds_read_b64_tr_b16 v[76:77], v10 offset:6144
  ds_read_b64_tr_b16 v[78:79], v10 offset:6656
  s_and_b32 s62, s52, 1
  s_bfe_u32 s63, s52, 0x10001
  s_lshl_b32 s64, s63, 12
  v_add_u32 v26, s64, v12
  s_lshl_b32 s64, s56, 1
  s_add_u32 s64, s64, s63
  s_mul_i32 s90, s64, 28672
  s_lshl_b32 s65, s57, 7
  s_add_u32 s90, s90, s65
  s_lshl_b32 s62, s62, 6
  s_add_u32 s90, s90, s62
  s_lshl_b32 s64, s64, 7
  s_add_u32 s64, s64, 16842752
  v_lshl_add_u32 v30, v102, 2, s64
  s_waitcnt lgkmcnt(6)
  v_mfma_f32_32x32x16_bf16 v[32:47], v[64:67], a[48:51], v[32:47]
  ds_read_b64_tr_b16 v[80:81], v0 offset:0
  ds_read_b64_tr_b16 v[82:83], v0 offset:512
  s_add_u32 m0, s10, 114688
  s_nop 0
  buffer_load_dwordx4 v4, s[32:35], s80 offen lds
  s_waitcnt lgkmcnt(6)
  v_mfma_f32_32x32x16_bf16 v[32:47], v[68:71], a[52:55], v[32:47]
  ds_read_b64_tr_b16 v[84:85], v0 offset:2048
  ds_read_b64_tr_b16 v[86:87], v0 offset:2560
  s_mov_b32 s48, s20
  s_mov_b32 s49, s21
  s_mov_b32 s50, 1835008
  s_mov_b32 s51, 0x20000
  s_waitcnt lgkmcnt(6)
  v_mfma_f32_32x32x16_bf16 v[32:47], v[72:75], a[56:59], v[32:47]
  ds_read_b64_tr_b16 v[88:89], v0 offset:4096
  ds_read_b64_tr_b16 v[90:91], v0 offset:4608
  s_add_u32 m0, s10, 122752
  s_nop 0
  buffer_load_dwordx4 v4, s[32:35], s80 offen offset:128 lds
  s_waitcnt lgkmcnt(6)
  v_mfma_f32_32x32x16_bf16 v[32:47], v[76:79], a[60:63], v[32:47]
  ds_read_b64_tr_b16 v[92:93], v0 offset:6144
  ds_read_b64_tr_b16 v[94:95], v0 offset:6656
  s_waitcnt lgkmcnt(6)
  v_mfma_f32_32x32x16_bf16 v[48:63], v[80:83], a[48:51], v[48:63]
  s_waitcnt vmcnt(4) lgkmcnt(0)
  s_barrier
  v_add_u32 v6, 0x10000, v6
  v_add_u32 v7, 0x10000, v7
  v_add_u32 v8, 0x10000, v8
  v_add_u32 v9, 0x10000, v9
  v_add_u32 v10, 0x10000, v10
  v_add_u32 v0, 0x10000, v0
  ds_read_b128 a[64:67], v6
  ds_read_b128 a[68:71], v7
  ds_read_b128 a[72:75], v8
  ds_read_b128 a[76:79], v9
  ds_read_b64_tr_b16 v[64:65], v10 offset:0
  ds_read_b64_tr_b16 v[66:67], v10 offset:512
  s_add_u32 m0, s11, 65536
  s_nop 0
  buffer_load_dwordx4 v2, s[28:31], s74 offen lds
  v_mfma_f32_32x32x16_bf16 v[48:63], v[84:87], a[52:55], v[48:63]
  ds_read_b64_tr_b16 v[68:69], v10 offset:2048
  ds_read_b64_tr_b16 v[70:71], v10 offset:2560
  v_mul_u32_u24 v29, 896, v102
  v_lshl_add_u32 v29, v103, 4, v29
  v_mul_u32_u24 v99, 896, v96
  v_lshl_add_u32 v18, v101, 4, v99
  v_add_u32 v19, 6144, v18
  v_add_u32 v20, 12288, v18
  v_add_u32 v21, 18432, v18
  v_mfma_f32_32x32x16_bf16 v[48:63], v[88:91], a[56:59], v[48:63]
  ds_read_b64_tr_b16 v[72:73], v10 offset:4096
  ds_read_b64_tr_b16 v[74:75], v10 offset:4608
  v_mfma_f32_32x32x16_bf16 v[48:63], v[92:95], a[60:63], v[48:63]
  ds_read_b64_tr_b16 v[76:77], v10 offset:6144
  ds_read_b64_tr_b16 v[78:79], v10 offset:6656
  s_add_u32 m0, s11, 65536
  s_nop 0
  buffer_load_dwordx4 v3, s[28:31], s74 offen offset:1024 lds
  s_waitcnt lgkmcnt(6)
  v_mfma_f32_32x32x16_bf16 v[32:47], v[64:67], a[64:67], v[32:47]
  ds_read_b64_tr_b16 v[80:81], v0 offset:0
  ds_read_b64_tr_b16 v[82:83], v0 offset:512
  s_add_u32 m0, s10, 81920
  s_nop 0
  buffer_load_dwordx4 v4, s[32:35], s81 offen lds
  s_waitcnt lgkmcnt(6)
  v_mfma_f32_32x32x16_bf16 v[32:47], v[68:71], a[68:71], v[32:47]
  ds_read_b64_tr_b16 v[84:85], v0 offset:2048
  ds_read_b64_tr_b16 v[86:87], v0 offset:2560
  s_waitcnt lgkmcnt(6)
  v_mfma_f32_32x32x16_bf16 v[32:47], v[72:75], a[72:75], v[32:47]
  ds_read_b64_tr_b16 v[88:89], v0 offset:4096
  ds_read_b64_tr_b16 v[90:91], v0 offset:4608
  s_add_u32 m0, s10, 89984
  s_nop 0
  buffer_load_dwordx4 v4, s[32:35], s81 offen offset:128 lds
  s_waitcnt lgkmcnt(6)
  v_mfma_f32_32x32x16_bf16 v[32:47], v[76:79], a[76:79], v[32:47]
  ds_read_b64_tr_b16 v[92:93], v0 offset:6144
  ds_read_b64_tr_b16 v[94:95], v0 offset:6656
  s_waitcnt lgkmcnt(6)
  v_mfma_f32_32x32x16_bf16 v[48:63], v[80:83], a[64:67], v[48:63]
  s_waitcnt vmcnt(4) lgkmcnt(0)
  s_barrier
  v_add_u32 v6, 0xffff8000, v6
  v_add_u32 v7, 0xffff8000, v7
  v_add_u32 v8, 0xffff8000, v8
  v_add_u32 v9, 0xffff8000, v9
  v_add_u32 v10, 0xffff8000, v10
  v_add_u32 v0, 0xffff8000, v0
  ds_read_b128 a[80:83], v6
  ds_read_b128 a[84:87], v7
  ds_read_b128 a[88:91], v8
  ds_read_b128 a[92:95], v9
  ds_read_b64_tr_b16 v[64:65], v10 offset:0
  ds_read_b64_tr_b16 v[66:67], v10 offset:512
  s_add_u32 s62, s75, 256
  s_add_u32 m0, s10, 0
  s_nop 0
  buffer_load_dwordx4 v4, s[32:35], s62 offen lds
  v_mfma_f32_32x32x16_bf16 v[48:63], v[84:87], a[68:71], v[48:63]
  ds_read_b64_tr_b16 v[68:69], v10 offset:2048
  ds_read_b64_tr_b16 v[70:71], v10 offset:2560
  s_add_u32 s62, s76, 256
  s_add_u32 m0, s10, 8192
  s_nop 0
  buffer_load_dwordx4 v4, s[32:35], s62 offen lds
  v_mfma_f32_32x32x16_bf16 v[48:63], v[88:91], a[72:75], v[48:63]
  ds_read_b64_tr_b16 v[72:73], v10 offset:4096
  ds_read_b64_tr_b16 v[74:75], v10 offset:4608
  v_mfma_f32_32x32x16_bf16 v[48:63], v[92:95], a[76:79], v[48:63]
  ds_read_b64_tr_b16 v[76:77], v10 offset:6144
  ds_read_b64_tr_b16 v[78:79], v10 offset:6656
  s_mov_b32 s84, 65536
  s_branch L_nchk_4
L_non_2:
  s_sleep 1
  global_load_dwordx2 v[16:17], v22, s[22:23] sc1
  s_waitcnt vmcnt(0)
L_nchk_4:
  v_readfirstlane_b32 s60, v16
  v_readfirstlane_b32 s61, v17
  s_nop 3
  s_cmp_lg_u32 s61, 0
  s_cbranch_scc1 L_nok_3
  s_sub_u32 s84, s84, 1
  s_cmp_lg_u32 s84, 0
  s_cbranch_scc1 L_non_2
L_nok_3:
  s_waitcnt lgkmcnt(6)
  v_mfma_f32_32x32x16_bf16 v[32:47], v[64:67], a[80:83], v[32:47]
  ds_read_b64_tr_b16 v[80:81], v0 offset:0
  ds_read_b64_tr_b16 v[82:83], v0 offset:512
  s_add_u32 s62, s77, 256
  s_add_u32 m0, s10, 16384
  s_nop 0
  buffer_load_dwordx4 v4, s[32:35], s62 offen lds
  s_waitcnt lgkmcnt(6)
  v_mfma_f32_32x32x16_bf16 v[32:47], v[68:71], a[84:87], v[32:47]
  ds_read_b64_tr_b16 v[84:85], v0 offset:2048
  ds_read_b64_tr_b16 v[86:87], v0 offset:2560
  s_waitcnt lgkmcnt(6)
  v_mfma_f32_32x32x16_bf16 v[32:47], v[72:75], a[88:91], v[32:47]
  ds_read_b64_tr_b16 v[88:89], v0 offset:4096
  ds_read_b64_tr_b16 v[90:91], v0 offset:4608
  s_add_u32 s62, s78, 256
  s_add_u32 m0, s10, 24576
  s_nop 0
  buffer_load_dwordx4 v4, s[32:35], s62 offen lds
  s_waitcnt lgkmcnt(6)
  v_mfma_f32_32x32x16_bf16 v[32:47], v[76:79], a[92:95], v[32:47]
  ds_read_b64_tr_b16 v[92:93], v0 offset:6144
  ds_read_b64_tr_b16 v[94:95], v0 offset:6656
  s_waitcnt lgkmcnt(6)
  v_mfma_f32_32x32x16_bf16 v[48:63], v[80:83], a[80:83], v[48:63]
  s_waitcnt vmcnt(4) lgkmcnt(0)
  s_barrier
  v_add_u32 v6, 0xffff8000, v6
  v_add_u32 v7, 0xffff8000, v7
  v_add_u32 v8, 0xffff8000, v8
  v_add_u32 v9, 0xffff8000, v9
  v_add_u32 v10, 0xffff8000, v10
  v_add_u32 v0, 0xffff8000, v0
  ds_read_b128 a[96:99], v6
  ds_read_b128 a[100:103], v7
  ds_read_b128 a[104:107], v8
  ds_read_b128 a[108:111], v9
  ds_read_b64_tr_b16 v[64:65], v10 offset:0
  ds_read_b64_tr_b16 v[66:67], v10 offset:512
  s_add_u32 s62, s79, 256
  s_add_u32 m0, s10, 32768
  s_nop 0
  buffer_load_dwordx4 v4, s[32:35], s62 offen lds
  v_mfma_f32_32x32x16_bf16 v[48:63], v[84:87], a[84:87], v[48:63]
  ds_read_b64_tr_b16 v[68:69], v10 offset:2048
  ds_read_b64_tr_b16 v[70:71], v10 offset:2560
  v_mfma_f32_32x32x16_bf16 v[48:63], v[88:91], a[88:91], v[48:63]
  ds_read_b64_tr_b16 v[72:73], v10 offset:4096
  ds_read_b64_tr_b16 v[74:75], v10 offset:4608
  v_mfma_f32_32x32x16_bf16 v[48:63], v[92:95], a[92:95], v[48:63]
  ds_read_b64_tr_b16 v[76:77], v10 offset:6144
  ds_read_b64_tr_b16 v[78:79], v10 offset:6656
  s_waitcnt lgkmcnt(6)
  v_mfma_f32_32x32x16_bf16 v[32:47], v[64:67], a[96:99], v[32:47]
  ds_read_b64_tr_b16 v[80:81], v0 offset:0
  ds_read_b64_tr_b16 v[82:83], v0 offset:512
  s_add_u32 s62, s80, 256
  s_add_u32 m0, s10, 40960
  s_nop 0
  buffer_load_dwordx4 v4, s[32:35], s62 offen lds
  s_waitcnt lgkmcnt(6)
  v_mfma_f32_32x32x16_bf16 v[32:47], v[68:71], a[100:103], v[32:47]
  ds_read_b64_tr_b16 v[84:85], v0 offset:2048
  ds_read_b64_tr_b16 v[86:87], v0 offset:2560
  s_waitcnt lgkmcnt(6)
  v_mfma_f32_32x32x16_bf16 v[32:47], v[72:75], a[104:107], v[32:47]
  ds_read_b64_tr_b16 v[88:89], v0 offset:4096
  ds_read_b64_tr_b16 v[90:91], v0 offset:4608
  s_waitcnt lgkmcnt(6)
  v_mfma_f32_32x32x16_bf16 v[32:47], v[76:79], a[108:111], v[32:47]
  ds_read_b64_tr_b16 v[92:93], v0 offset:6144
  ds_read_b64_tr_b16 v[94:95], v0 offset:6656
  s_waitcnt lgkmcnt(6)
  v_mfma_f32_32x32x16_bf16 v[48:63], v[80:83], a[96:99], v[48:63]
  s_add_u32 s62, s81, 256
  s_add_u32 m0, s10, 49152
  s_nop 0
  buffer_load_dwordx4 v4, s[32:35], s62 offen lds
  s_waitcnt lgkmcnt(4)
  v_mfma_f32_32x32x16_bf16 v[48:63], v[84:87], a[100:103], v[48:63]
  s_waitcnt lgkmcnt(2)
  v_mfma_f32_32x32x16_bf16 v[48:63], v[88:91], a[104:107], v[48:63]
  s_waitcnt lgkmcnt(0)
  v_mfma_f32_32x32x16_bf16 v[48:63], v[92:95], a[108:111], v[48:63]
  s_cmp_lg_u32 s93, 0
  s_cbranch_scc1 L_ffnB
  s_nop 3
  v_mul_f32 v96, s26, v32
  v_mul_f32 v97, s26, v33
  v_mul_f32 v98, s26, v34
  v_mul_f32 v99, s26, v35
  v_mul_f32 v100, s26, v36
  v_mul_f32 v101, s26, v37
  v_mul_f32 v102, s26, v38
  v_mul_f32 v103, s26, v39
  v_exp_f32 v96, v96
  v_exp_f32 v97, v97
  v_exp_f32 v98, v98
  v_exp_f32 v99, v99
  v_exp_f32 v100, v100
  v_exp_f32 v101, v101
  v_exp_f32 v102, v102
  v_exp_f32 v103, v103
  v_fma_f32 v104, v96, 0.5, 1.0
  v_fma_f32 v105, v97, 0.5, 1.0
  v_fma_f32 v106, v98, 0.5, 1.0
  v_fma_f32 v107, v99, 0.5, 1.0
  v_fma_f32 v108, v100, 0.5, 1.0
  v_fma_f32 v109, v101, 0.5, 1.0
  v_fma_f32 v110, v102, 0.5, 1.0
  v_fma_f32 v111, v103, 0.5, 1.0
  v_fma_f32 v96, v96, v104, 1.0
  v_fma_f32 v97, v97, v105, 1.0
  v_fma_f32 v98, v98, v106, 1.0
  v_fma_f32 v99, v99, v107, 1.0
  v_fma_f32 v100, v100, v108, 1.0
  v_fma_f32 v101, v101, v109, 1.0
  v_fma_f32 v102, v102, v110, 1.0
  v_fma_f32 v103, v103, v111, 1.0
  v_rcp_f32 v96, v96
  v_rcp_f32 v97, v97
  v_rcp_f32 v98, v98
  v_rcp_f32 v99, v99
  v_rcp_f32 v100, v100
  v_rcp_f32 v101, v101
  v_rcp_f32 v102, v102
  v_rcp_f32 v103, v103
  v_fma_f32 v96, -v32, v96, v32
  v_fma_f32 v97, -v33, v97, v33
  v_fma_f32 v98, -v34, v98, v34
  v_fma_f32 v99, -v35, v99, v35
  v_fma_f32 v100, -v36, v100, v36
  v_fma_f32 v101, -v37, v101, v37
  v_fma_f32 v102, -v38, v102, v38
  v_fma_f32 v103, -v39, v103, v39
  v_cvt_pk_bf16_f32 v120, v96, v97
  v_cvt_pk_bf16_f32 v121, v98, v99
  v_cvt_pk_bf16_f32 v122, v100, v101
  v_cvt_pk_bf16_f32 v123, v102, v103
  s_add_u32 s62, s100, 32768
  buffer_store_dwordx4 v[120:123], v12, s[44:47], s62 offen sc0 sc1
  v_mul_f32 v96, s26, v40
  v_mul_f32 v97, s26, v41
  v_mul_f32 v98, s26, v42
  v_mul_f32 v99, s26, v43
  v_mul_f32 v100, s26, v44
  v_mul_f32 v101, s26, v45
  v_mul_f32 v102, s26, v46
  v_mul_f32 v103, s26, v47
  v_exp_f32 v96, v96
  v_exp_f32 v97, v97
  v_exp_f32 v98, v98
  v_exp_f32 v99, v99
  v_exp_f32 v100, v100
  v_exp_f32 v101, v101
  v_exp_f32 v102, v102
  v_exp_f32 v103, v103
  v_fma_f32 v104, v96, 0.5, 1.0
  v_fma_f32 v105, v97, 0.5, 1.0
  v_fma_f32 v106, v98, 0.5, 1.0
  v_fma_f32 v107, v99, 0.5, 1.0
  v_fma_f32 v108, v100, 0.5, 1.0
  v_fma_f32 v109, v101, 0.5, 1.0
  v_fma_f32 v110, v102, 0.5, 1.0
  v_fma_f32 v111, v103, 0.5, 1.0
  v_fma_f32 v96, v96, v104, 1.0
  v_fma_f32 v97, v97, v105, 1.0
  v_fma_f32 v98, v98, v106, 1.0
  v_fma_f32 v99, v99, v107, 1.0
  v_fma_f32 v100, v100, v108, 1.0
  v_fma_f32 v101, v101, v109, 1.0
  v_fma_f32 v102, v102, v110, 1.0
  v_fma_f32 v103, v103, v111, 1.0
  v_rcp_f32 v96, v96
  v_rcp_f32 v97, v97
  v_rcp_f32 v98, v98
  v_rcp_f32 v99, v99
  v_rcp_f32 v100, v100
  v_rcp_f32 v101, v101
  v_rcp_f32 v102, v102
  v_rcp_f32 v103, v103
  v_fma_f32 v96, -v40, v96, v40
  v_fma_f32 v97, -v41, v97, v41
  v_fma_f32 v98, -v42, v98, v42
  v_fma_f32 v99, -v43, v99, v43
  v_fma_f32 v100, -v44, v100, v44
  v_fma_f32 v101, -v45, v101, v45
  v_fma_f32 v102, -v46, v102, v46
  v_fma_f32 v103, -v47, v103, v47
  v_cvt_pk_bf16_f32 v124, v96, v97
  v_cvt_pk_bf16_f32 v125, v98, v99
  v_cvt_pk_bf16_f32 v126, v100, v101
  v_cvt_pk_bf16_f32 v127, v102, v103
  s_add_u32 s62, s100, 33792
  buffer_store_dwordx4 v[124:127], v12, s[44:47], s62 offen sc0 sc1
  s_waitcnt vmcnt(2)
  s_barrier
  v_mul_f32 v96, s26, v48
  v_mul_f32 v97, s26, v49
  v_mul_f32 v98, s26, v50
  v_mul_f32 v99, s26, v51
  v_mul_f32 v100, s26, v52
  v_mul_f32 v101, s26, v53
  v_mul_f32 v102, s26, v54
  v_mul_f32 v103, s26, v55
  v_exp_f32 v96, v96
  v_exp_f32 v97, v97
  v_exp_f32 v98, v98
  v_exp_f32 v99, v99
  v_exp_f32 v100, v100
  v_exp_f32 v101, v101
  v_exp_f32 v102, v102
  v_exp_f32 v103, v103
  v_fma_f32 v104, v96, 0.5, 1.0
  v_fma_f32 v105, v97, 0.5, 1.0
  v_fma_f32 v106, v98, 0.5, 1.0
  v_fma_f32 v107, v99, 0.5, 1.0
  v_fma_f32 v108, v100, 0.5, 1.0
  v_fma_f32 v109, v101, 0.5, 1.0
  v_fma_f32 v110, v102, 0.5, 1.0
  v_fma_f32 v111, v103, 0.5, 1.0
  v_fma_f32 v96, v96, v104, 1.0
  v_fma_f32 v97, v97, v105, 1.0
  v_fma_f32 v98, v98, v106, 1.0
  v_fma_f32 v99, v99, v107, 1.0
  v_fma_f32 v100, v100, v108, 1.0
  v_fma_f32 v101, v101, v109, 1.0
  v_fma_f32 v102, v102, v110, 1.0
  v_fma_f32 v103, v103, v111, 1.0
  v_rcp_f32 v96, v96
  v_rcp_f32 v97, v97
  v_rcp_f32 v98, v98
  v_rcp_f32 v99, v99
  v_rcp_f32 v100, v100
  v_rcp_f32 v101, v101
  v_rcp_f32 v102, v102
  v_rcp_f32 v103, v103
  v_fma_f32 v96, -v48, v96, v48
  v_fma_f32 v97, -v49, v97, v49
  v_fma_f32 v98, -v50, v98, v50
  v_fma_f32 v99, -v51, v99, v51
  v_fma_f32 v100, -v52, v100, v52
  v_fma_f32 v101, -v53, v101, v53
  v_fma_f32 v102, -v54, v102, v54
  v_fma_f32 v103, -v55, v103, v55
  v_cvt_pk_bf16_f32 v120, v96, v97
  v_cvt_pk_bf16_f32 v121, v98, v99
  v_cvt_pk_bf16_f32 v122, v100, v101
  v_cvt_pk_bf16_f32 v123, v102, v103
  s_add_u32 s62, s100, 34816
  buffer_store_dwordx4 v[120:123], v12, s[44:47], s62 offen sc0 sc1
  v_mul_f32 v96, s26, v56
  v_mul_f32 v97, s26, v57
  v_mul_f32 v98, s26, v58
  v_mul_f32 v99, s26, v59
  v_mul_f32 v100, s26, v60
  v_mul_f32 v101, s26, v61
  v_mul_f32 v102, s26, v62
  v_mul_f32 v103, s26, v63
  v_exp_f32 v96, v96
  v_exp_f32 v97, v97
  v_exp_f32 v98, v98
  v_exp_f32 v99, v99
  v_exp_f32 v100, v100
  v_exp_f32 v101, v101
  v_exp_f32 v102, v102
  v_exp_f32 v103, v103
  v_fma_f32 v104, v96, 0.5, 1.0
  v_fma_f32 v105, v97, 0.5, 1.0
  v_fma_f32 v106, v98, 0.5, 1.0
  v_fma_f32 v107, v99, 0.5, 1.0
  v_fma_f32 v108, v100, 0.5, 1.0
  v_fma_f32 v109, v101, 0.5, 1.0
  v_fma_f32 v110, v102, 0.5, 1.0
  v_fma_f32 v111, v103, 0.5, 1.0
  v_fma_f32 v96, v96, v104, 1.0
  v_fma_f32 v97, v97, v105, 1.0
  v_fma_f32 v98, v98, v106, 1.0
  v_fma_f32 v99, v99, v107, 1.0
  v_fma_f32 v100, v100, v108, 1.0
  v_fma_f32 v101, v101, v109, 1.0
  v_fma_f32 v102, v102, v110, 1.0
  v_fma_f32 v103, v103, v111, 1.0
  v_rcp_f32 v96, v96
  v_rcp_f32 v97, v97
  v_rcp_f32 v98, v98
  v_rcp_f32 v99, v99
  v_rcp_f32 v100, v100
  v_rcp_f32 v101, v101
  ds_read_b64_tr_b16 v[64:65], v11 offset:0
  ds_read_b64_tr_b16 v[66:67], v11 offset:512
  ds_read_b64_tr_b16 v[68:69], v11 offset:2048
  ds_read_b64_tr_b16 v[70:71], v11 offset:2560
  ds_read_b64_tr_b16 v[72:73], v11 offset:4096
  ds_read_b64_tr_b16 v[74:75], v11 offset:4608
  ds_read_b64_tr_b16 v[76:77], v11 offset:6144
  ds_read_b64_tr_b16 v[78:79], v11 offset:6656
  v_rcp_f32 v102, v102
  v_rcp_f32 v103, v103
  v_fma_f32 v96, -v56, v96, v56
  v_fma_f32 v97, -v57, v97, v57
  v_fma_f32 v98, -v58, v98, v58
  v_fma_f32 v99, -v59, v99, v59
  v_fma_f32 v100, -v60, v100, v60
  v_fma_f32 v101, -v61, v101, v61
  v_fma_f32 v102, -v62, v102, v62
  v_fma_f32 v103, -v63, v103, v63
  v_cvt_pk_bf16_f32 v124, v96, v97
  v_cvt_pk_bf16_f32 v125, v98, v99
  v_cvt_pk_bf16_f32 v126, v100, v101
  v_cvt_pk_bf16_f32 v127, v102, v103
  s_add_u32 s62, s100, 35840
  buffer_store_dwordx4 v[124:127], v12, s[44:47], s62 offen sc0 sc1
  v_mov_b32 v116, v14
  s_nop 1
  v_mfma_f32_32x32x16_bf16 v[32:47], v[116:119], v[112:115], 0
  s_waitcnt lgkmcnt(6)
  v_mfma_f32_32x32x16_bf16 v[32:47], v[64:67], a[0:3], v[32:47]
  ds_read_b64_tr_b16 v[80:81], v11 offset:8192
  ds_read_b64_tr_b16 v[82:83], v11 offset:8704
  s_waitcnt lgkmcnt(6)
  v_mfma_f32_32x32x16_bf16 v[32:47], v[68:71], a[4:7], v[32:47]
  ds_read_b64_tr_b16 v[84:85], v11 offset:10240
  ds_read_b64_tr_b16 v[86:87], v11 offset:10752
  s_waitcnt lgkmcnt(6)
  v_mfma_f32_32x32x16_bf16 v[32:47], v[72:75], a[8:11], v[32:47]
  ds_read_b64_tr_b16 v[88:89], v11 offset:12288
  ds_read_b64_tr_b16 v[90:91], v11 offset:12800
  s_waitcnt lgkmcnt(6)
  v_mfma_f32_32x32x16_bf16 v[32:47], v[76:79], a[12:15], v[32:47]
  ds_read_b64_tr_b16 v[92:93], v11 offset:14336
  ds_read_b64_tr_b16 v[94:95], v11 offset:14848
  s_waitcnt lgkmcnt(6)
  v_mfma_f32_32x32x16_bf16 v[32:47], v[80:83], a[16:19], v[32:47]
  ds_read_b64_tr_b16 v[64:65], v11 offset:16384
  ds_read_b64_tr_b16 v[66:67], v11 offset:16896
  s_waitcnt lgkmcnt(6)
  v_mfma_f32_32x32x16_bf16 v[32:47], v[84:87], a[20:23], v[32:47]
  ds_read_b64_tr_b16 v[68:69], v11 offset:18432
  ds_read_b64_tr_b16 v[70:71], v11 offset:18944
  s_waitcnt lgkmcnt(6)
  v_mfma_f32_32x32x16_bf16 v[32:47], v[88:91], a[24:27], v[32:47]
  ds_read_b64_tr_b16 v[72:73], v11 offset:20480
  ds_read_b64_tr_b16 v[74:75], v11 offset:20992
  s_waitcnt lgkmcnt(6)
  v_mfma_f32_32x32x16_bf16 v[32:47], v[92:95], a[28:31], v[32:47]
  ds_read_b64_tr_b16 v[76:77], v11 offset:22528
  ds_read_b64_tr_b16 v[78:79], v11 offset:23040
  s_waitcnt lgkmcnt(6)
  v_mfma_f32_32x32x16_bf16 v[32:47], v[64:67], a[32:35], v[32:47]
  ds_read_b64_tr_b16 v[80:81], v11 offset:24576
  ds_read_b64_tr_b16 v[82:83], v11 offset:25088
  s_waitcnt lgkmcnt(6)
  v_mfma_f32_32x32x16_bf16 v[32:47], v[68:71], a[36:39], v[32:47]
  ds_read_b64_tr_b16 v[84:85], v11 offset:26624
  ds_read_b64_tr_b16 v[86:87], v11 offset:27136
  s_waitcnt lgkmcnt(6)
  v_mfma_f32_32x32x16_bf16 v[32:47], v[72:75], a[40:43], v[32:47]
  ds_read_b64_tr_b16 v[88:89], v11 offset:28672
  ds_read_b64_tr_b16 v[90:91], v11 offset:29184
  s_waitcnt lgkmcnt(6)
  v_mfma_f32_32x32x16_bf16 v[32:47], v[76:79], a[44:47], v[32:47]
  ds_read_b64_tr_b16 v[92:93], v11 offset:30720
  ds_read_b64_tr_b16 v[94:95], v11 offset:31232
  s_waitcnt lgkmcnt(6)
  v_mfma_f32_32x32x16_bf16 v[32:47], v[80:83], a[48:51], v[32:47]
  ds_read_b64_tr_b16 v[64:65], v11 offset:32768
  ds_read_b64_tr_b16 v[66:67], v11 offset:33280
  s_waitcnt lgkmcnt(6)
  v_mfma_f32_32x32x16_bf16 v[32:47], v[84:87], a[52:55], v[32:47]
  ds_read_b64_tr_b16 v[68:69], v11 offset:34816
  ds_read_b64_tr_b16 v[70:71], v11 offset:35328
  s_waitcnt lgkmcnt(6)
  v_mfma_f32_32x32x16_bf16 v[32:47], v[88:91], a[56:59], v[32:47]
  ds_read_b64_tr_b16 v[72:73], v11 offset:36864
  ds_read_b64_tr_b16 v[74:75], v11 offset:37376
  s_waitcnt lgkmcnt(6)
  v_mfma_f32_32x32x16_bf16 v[32:47], v[92:95], a[60:63], v[32:47]
  ds_read_b64_tr_b16 v[76:77], v11 offset:38912
  ds_read_b64_tr_b16 v[78:79], v11 offset:39424
  s_waitcnt lgkmcnt(6)
  v_mfma_f32_32x32x16_bf16 v[32:47], v[64:67], a[64:67], v[32:47]
  ds_read_b64_tr_b16 v[80:81], v11 offset:40960
  ds_read_b64_tr_b16 v[82:83], v11 offset:41472
  s_waitcnt lgkmcnt(6)
  v_mfma_f32_32x32x16_bf16 v[32:47], v[68:71], a[68:71], v[32:47]
  ds_read_b64_tr_b16 v[84:85], v11 offset:43008
  ds_read_b64_tr_b16 v[86:87], v11 offset:43520
  s_waitcnt lgkmcnt(6)
  v_mfma_f32_32x32x16_bf16 v[32:47], v[72:75], a[72:75], v[32:47]
  ds_read_b64_tr_b16 v[88:89], v11 offset:45056
  ds_read_b64_tr_b16 v[90:91], v11 offset:45568
  s_waitcnt lgkmcnt(6)
  v_mfma_f32_32x32x16_bf16 v[32:47], v[76:79], a[76:79], v[32:47]
  ds_read_b64_tr_b16 v[92:93], v11 offset:47104
  ds_read_b64_tr_b16 v[94:95], v11 offset:47616
  s_waitcnt lgkmcnt(6)
  v_mfma_f32_32x32x16_bf16 v[32:47], v[80:83], a[80:83], v[32:47]
  ds_read_b64_tr_b16 v[64:65], v11 offset:49152
  ds_read_b64_tr_b16 v[66:67], v11 offset:49664
  s_waitcnt lgkmcnt(6)
  v_mfma_f32_32x32x16_bf16 v[32:47], v[84:87], a[84:87], v[32:47]
  ds_read_b64_tr_b16 v[68:69], v11 offset:51200
  ds_read_b64_tr_b16 v[70:71], v11 offset:51712
  s_waitcnt lgkmcnt(6)
  v_mfma_f32_32x32x16_bf16 v[32:47], v[88:91], a[88:91], v[32:47]
  ds_read_b64_tr_b16 v[72:73], v11 offset:53248
  ds_read_b64_tr_b16 v[74:75], v11 offset:53760
  s_waitcnt lgkmcnt(6)
  v_mfma_f32_32x32x16_bf16 v[32:47], v[92:95], a[92:95], v[32:47]
  ds_read_b64_tr_b16 v[76:77], v11 offset:55296
  ds_read_b64_tr_b16 v[78:79], v11 offset:55808
  s_waitcnt lgkmcnt(6)
  v_mfma_f32_32x32x16_bf16 v[32:47], v[64:67], a[96:99], v[32:47]
  s_waitcnt vmcnt(0)
  v_mov_b32 v24, 1
  s_mov_b64 exec, 1
  ds_add_rtn_u32 v25, v22, v24 offset:57344
  s_mov_b64 exec, -1
  s_waitcnt lgkmcnt(5)
  v_mfma_f32_32x32x16_bf16 v[32:47], v[68:71], a[100:103], v[32:47]
  s_waitcnt lgkmcnt(3)
  v_mfma_f32_32x32x16_bf16 v[32:47], v[72:75], a[104:107], v[32:47]
  s_waitcnt lgkmcnt(1)
  v_mfma_f32_32x32x16_bf16 v[32:47], v[76:79], a[108:111], v[32:47]
  s_waitcnt lgkmcnt(0)
  v_readfirstlane_b32 s62, v25
  s_nop 3
  s_cmp_lg_u32 s62, 3
  s_cbranch_scc1 L_skip_5
  s_lshl_b32 s62, s53, 9
  s_lshl_b32 s63, s58, 3
  s_add_u32 s62, s62, s63
  s_add_u32 s62, s62, 16852992
  v_mov_b32 v24, s60
  v_mov_b32 v25, s61
  s_mov_b64 exec, 1
  buffer_store_dwordx2 v[24:25], v22, s[44:47], s62 offen sc0 sc1
  s_mov_b64 exec, -1
L_skip_5:
  s_barrier
  ds_read_b64_tr_b16 v[64:65], v31 offset:0
  ds_read_b64_tr_b16 v[66:67], v31 offset:256
  ds_read_b64_tr_b16 v[68:69], v31 offset:1024
  ds_read_b64_tr_b16 v[70:71], v31 offset:1280
  ds_read_b64_tr_b16 v[72:73], v31 offset:2048
  ds_read_b64_tr_b16 v[74:75], v31 offset:2304
  ds_read_b64_tr_b16 v[76:77], v31 offset:3072
  ds_read_b64_tr_b16 v[78:79], v31 offset:3328
  v_mov_b32 v116, v15
  s_nop 1
  v_mfma_f32_32x32x16_bf16 v[48:63], v[116:119], v[112:115], 0
  s_waitcnt lgkmcnt(6)
  v_mfma_f32_32x32x16_bf16 v[48:63], v[64:67], a[0:3], v[48:63]
  ds_read_b64_tr_b16 v[80:81], v31 offset:4096
  ds_read_b64_tr_b16 v[82:83], v31 offset:4352
  s_waitcnt lgkmcnt(6)
  v_mfma_f32_32x32x16_bf16 v[48:63], v[68:71], a[4:7], v[48:63]
  ds_read_b64_tr_b16 v[84:85], v31 offset:5120
  ds_read_b64_tr_b16 v[86:87], v31 offset:5376
  s_waitcnt lgkmcnt(6)
  v_mfma_f32_32x32x16_bf16 v[48:63], v[72:75], a[8:11], v[48:63]
  ds_read_b64_tr_b16 v[88:89], v31 offset:6144
  ds_read_b64_tr_b16 v[90:91], v31 offset:6400
  s_waitcnt lgkmcnt(6)
  v_mfma_f32_32x32x16_bf16 v[48:63], v[76:79], a[12:15], v[48:63]
  ds_read_b64_tr_b16 v[92:93], v31 offset:7168
  ds_read_b64_tr_b16 v[94:95], v31 offset:7424
  s_waitcnt lgkmcnt(6)
  v_mfma_f32_32x32x16_bf16 v[48:63], v[80:83], a[16:19], v[48:63]
  ds_read_b64_tr_b16 v[64:65], v31 offset:8192
  ds_read_b64_tr_b16 v[66:67], v31 offset:8448
  s_waitcnt lgkmcnt(6)
  v_mfma_f32_32x32x16_bf16 v[48:63], v[84:87], a[20:23], v[48:63]
  ds_read_b64_tr_b16 v[68:69], v31 offset:9216
  ds_read_b64_tr_b16 v[70:71], v31 offset:9472
  s_waitcnt lgkmcnt(6)
  v_mfma_f32_32x32x16_bf16 v[48:63], v[88:91], a[24:27], v[48:63]
  ds_read_b64_tr_b16 v[72:73], v31 offset:10240
  ds_read_b64_tr_b16 v[74:75], v31 offset:10496
  s_waitcnt lgkmcnt(6)
  v_mfma_f32_32x32x16_bf16 v[48:63], v[92:95], a[28:31], v[48:63]
  ds_read_b64_tr_b16 v[76:77], v31 offset:11264
  ds_read_b64_tr_b16 v[78:79], v31 offset:11520
  s_waitcnt lgkmcnt(6)
  v_mfma_f32_32x32x16_bf16 v[48:63], v[64:67], a[32:35], v[48:63]
  ds_read_b64_tr_b16 v[80:81], v31 offset:12288
  ds_read_b64_tr_b16 v[82:83], v31 offset:12544
  s_waitcnt lgkmcnt(6)
  v_mfma_f32_32x32x16_bf16 v[48:63], v[68:71], a[36:39], v[48:63]
  ds_read_b64_tr_b16 v[84:85], v31 offset:13312
  ds_read_b64_tr_b16 v[86:87], v31 offset:13568
  s_waitcnt lgkmcnt(6)
  v_mfma_f32_32x32x16_bf16 v[48:63], v[72:75], a[40:43], v[48:63]
  ds_read_b64_tr_b16 v[88:89], v31 offset:14336
  ds_read_b64_tr_b16 v[90:91], v31 offset:14592
  s_waitcnt lgkmcnt(6)
  v_mfma_f32_32x32x16_bf16 v[48:63], v[76:79], a[44:47], v[48:63]
  ds_read_b64_tr_b16 v[92:93], v31 offset:15360
  ds_read_b64_tr_b16 v[94:95], v31 offset:15616
  s_waitcnt lgkmcnt(6)
  v_mfma_f32_32x32x16_bf16 v[48:63], v[80:83], a[48:51], v[48:63]
  ds_read_b64_tr_b16 v[64:65], v31 offset:16384
  ds_read_b64_tr_b16 v[66:67], v31 offset:16640
  s_waitcnt lgkmcnt(6)
  v_mfma_f32_32x32x16_bf16 v[48:63], v[84:87], a[52:55], v[48:63]
  ds_read_b64_tr_b16 v[68:69], v31 offset:17408
  ds_read_b64_tr_b16 v[70:71], v31 offset:17664
  s_waitcnt lgkmcnt(6)
  v_mfma_f32_32x32x16_bf16 v[48:63], v[88:91], a[56:59], v[48:63]
  ds_read_b64_tr_b16 v[72:73], v31 offset:18432
  ds_read_b64_tr_b16 v[74:75], v31 offset:18688
  s_waitcnt lgkmcnt(6)
  v_mfma_f32_32x32x16_bf16 v[48:63], v[92:95], a[60:63], v[48:63]
  ds_read_b64_tr_b16 v[76:77], v31 offset:19456
  ds_read_b64_tr_b16 v[78:79], v31 offset:19712
  s_waitcnt lgkmcnt(6)
  v_mfma_f32_32x32x16_bf16 v[48:63], v[64:67], a[64:67], v[48:63]
  ds_read_b64_tr_b16 v[80:81], v31 offset:20480
  ds_read_b64_tr_b16 v[82:83], v31 offset:20736
  s_waitcnt lgkmcnt(6)
  v_mfma_f32_32x32x16_bf16 v[48:63], v[68:71], a[68:71], v[48:63]
  ds_read_b64_tr_b16 v[84:85], v31 offset:21504
  ds_read_b64_tr_b16 v[86:87], v31 offset:21760
  s_waitcnt lgkmcnt(6)
  v_mfma_f32_32x32x16_bf16 v[48:63], v[72:75], a[72:75], v[48:63]
  ds_read_b64_tr_b16 v[88:89], v31 offset:22528
  ds_read_b64_tr_b16 v[90:91], v31 offset:22784
  s_waitcnt lgkmcnt(6)
  v_mfma_f32_32x32x16_bf16 v[48:63], v[76:79], a[76:79], v[48:63]
  ds_read_b64_tr_b16 v[92:93], v31 offset:23552
  ds_read_b64_tr_b16 v[94:95], v31 offset:23808
  s_waitcnt lgkmcnt(6)
  v_mfma_f32_32x32x16_bf16 v[48:63], v[80:83], a[80:83], v[48:63]
  ds_read_b64_tr_b16 v[64:65], v31 offset:24576
  ds_read_b64_tr_b16 v[66:67], v31 offset:24832
  s_waitcnt lgkmcnt(6)
  v_mfma_f32_32x32x16_bf16 v[48:63], v[84:87], a[84:87], v[48:63]
  ds_read_b64_tr_b16 v[68:69], v31 offset:25600
  ds_read_b64_tr_b16 v[70:71], v31 offset:25856
  s_waitcnt lgkmcnt(6)
  v_mfma_f32_32x32x16_bf16 v[48:63], v[88:91], a[88:91], v[48:63]
  ds_read_b64_tr_b16 v[72:73], v31 offset:26624
  ds_read_b64_tr_b16 v[74:75], v31 offset:26880
  s_waitcnt lgkmcnt(6)
  v_mfma_f32_32x32x16_bf16 v[48:63], v[92:95], a[92:95], v[48:63]
  ds_read_b64_tr_b16 v[76:77], v31 offset:27648
  ds_read_b64_tr_b16 v[78:79], v31 offset:27904
  s_waitcnt lgkmcnt(6)
  v_mfma_f32_32x32x16_bf16 v[48:63], v[64:67], a[96:99], v[48:63]
  s_waitcnt lgkmcnt(4)
  v_mfma_f32_32x32x16_bf16 v[48:63], v[68:71], a[100:103], v[48:63]
  s_waitcnt lgkmcnt(2)
  v_mfma_f32_32x32x16_bf16 v[48:63], v[72:75], a[104:107], v[48:63]
  s_waitcnt lgkmcnt(0)
  v_mfma_f32_32x32x16_bf16 v[48:63], v[76:79], a[108:111], v[48:63]
  s_barrier
  s_nop 3
  v_pk_mul_f32 v[96:97], s[26:27], v[32:33]
  v_pk_mul_f32 v[98:99], s[26:27], v[34:35]
  v_pk_mul_f32 v[100:101], s[26:27], v[36:37]
  v_pk_mul_f32 v[102:103], s[26:27], v[38:39]
  v_exp_f32 v96, v96
  v_exp_f32 v97, v97
  v_exp_f32 v98, v98
  v_exp_f32 v99, v99
  v_exp_f32 v100, v100
  v_exp_f32 v101, v101
  v_exp_f32 v102, v102
  v_exp_f32 v103, v103
  v_pk_fma_f32 v[104:105], v[96:97], 0.5, 1.0 op_sel_hi:[1,0,0]
  v_pk_fma_f32 v[106:107], v[98:99], 0.5, 1.0 op_sel_hi:[1,0,0]
  v_pk_fma_f32 v[108:109], v[100:101], 0.5, 1.0 op_sel_hi:[1,0,0]
  v_pk_fma_f32 v[110:111], v[102:103], 0.5, 1.0 op_sel_hi:[1,0,0]
  v_pk_fma_f32 v[96:97], v[96:97], v[104:105], 1.0 op_sel_hi:[1,1,0]
  v_pk_fma_f32 v[98:99], v[98:99], v[106:107], 1.0 op_sel_hi:[1,1,0]
  v_pk_fma_f32 v[100:101], v[100:101], v[108:109], 1.0 op_sel_hi:[1,1,0]
  v_pk_fma_f32 v[102:103], v[102:103], v[110:111], 1.0 op_sel_hi:[1,1,0]
  v_rcp_f32 v96, v96
  v_rcp_f32 v97, v97
  v_rcp_f32 v98, v98
  v_rcp_f32 v99, v99
  v_rcp_f32 v100, v100
  v_rcp_f32 v101, v101
  v_rcp_f32 v102, v102
  v_rcp_f32 v103, v103
  v_pk_fma_f32 v[96:97], v[32:33], v[96:97], v[32:33] neg_lo:[1,0,0] neg_hi:[1,0,0]
  v_pk_fma_f32 v[98:99], v[34:35], v[98:99], v[34:35] neg_lo:[1,0,0] neg_hi:[1,0,0]
  v_pk_fma_f32 v[100:101], v[36:37], v[100:101], v[36:37] neg_lo:[1,0,0] neg_hi:[1,0,0]
  v_pk_fma_f32 v[102:103], v[38:39], v[102:103], v[38:39] neg_lo:[1,0,0] neg_hi:[1,0,0]
  v_cvt_pk_bf16_f32 v120, v96, v97
  v_cvt_pk_bf16_f32 v121, v98, v99
  v_cvt_pk_bf16_f32 v122, v100, v101
  v_cvt_pk_bf16_f32 v123, v102, v103
  s_add_u32 s62, s97, 32768
  buffer_store_dwordx4 v[120:123], v12, s[44:47], s62 offen sc0 sc1
  v_pk_mul_f32 v[96:97], s[26:27], v[40:41]
  v_pk_mul_f32 v[98:99], s[26:27], v[42:43]
  v_pk_mul_f32 v[100:101], s[26:27], v[44:45]
  v_pk_mul_f32 v[102:103], s[26:27], v[46:47]
  v_exp_f32 v96, v96
  v_exp_f32 v97, v97
  v_exp_f32 v98, v98
  v_exp_f32 v99, v99
  v_exp_f32 v100, v100
  v_exp_f32 v101, v101
  v_exp_f32 v102, v102
  v_exp_f32 v103, v103
  v_pk_fma_f32 v[104:105], v[96:97], 0.5, 1.0 op_sel_hi:[1,0,0]
  v_pk_fma_f32 v[106:107], v[98:99], 0.5, 1.0 op_sel_hi:[1,0,0]
  v_pk_fma_f32 v[108:109], v[100:101], 0.5, 1.0 op_sel_hi:[1,0,0]
  v_pk_fma_f32 v[110:111], v[102:103], 0.5, 1.0 op_sel_hi:[1,0,0]
  v_pk_fma_f32 v[96:97], v[96:97], v[104:105], 1.0 op_sel_hi:[1,1,0]
  v_pk_fma_f32 v[98:99], v[98:99], v[106:107], 1.0 op_sel_hi:[1,1,0]
  v_pk_fma_f32 v[100:101], v[100:101], v[108:109], 1.0 op_sel_hi:[1,1,0]
  v_pk_fma_f32 v[102:103], v[102:103], v[110:111], 1.0 op_sel_hi:[1,1,0]
  v_rcp_f32 v96, v96
  v_rcp_f32 v97, v97
  v_rcp_f32 v98, v98
  v_rcp_f32 v99, v99
  v_rcp_f32 v100, v100
  v_rcp_f32 v101, v101
  v_rcp_f32 v102, v102
  v_rcp_f32 v103, v103
  v_pk_fma_f32 v[96:97], v[40:41], v[96:97], v[40:41] neg_lo:[1,0,0] neg_hi:[1,0,0]
  v_pk_fma_f32 v[98:99], v[42:43], v[98:99], v[42:43] neg_lo:[1,0,0] neg_hi:[1,0,0]
  v_pk_fma_f32 v[100:101], v[44:45], v[100:101], v[44:45] neg_lo:[1,0,0] neg_hi:[1,0,0]
  v_pk_fma_f32 v[102:103], v[46:47], v[102:103], v[46:47] neg_lo:[1,0,0] neg_hi:[1,0,0]
  v_cvt_pk_bf16_f32 v124, v96, v97
  v_cvt_pk_bf16_f32 v125, v98, v99
  v_cvt_pk_bf16_f32 v126, v100, v101
  v_cvt_pk_bf16_f32 v127, v102, v103
  s_add_u32 s62, s97, 33792
  buffer_store_dwordx4 v[124:127], v12, s[44:47], s62 offen sc0 sc1
  v_pk_mul_f32 v[96:97], s[26:27], v[48:49]
  v_pk_mul_f32 v[98:99], s[26:27], v[50:51]
  v_pk_mul_f32 v[100:101], s[26:27], v[52:53]
  v_pk_mul_f32 v[102:103], s[26:27], v[54:55]
  v_exp_f32 v96, v96
  v_exp_f32 v97, v97
  v_exp_f32 v98, v98
  v_exp_f32 v99, v99
  v_exp_f32 v100, v100
  v_exp_f32 v101, v101
  v_exp_f32 v102, v102
  v_exp_f32 v103, v103
  v_pk_fma_f32 v[104:105], v[96:97], 0.5, 1.0 op_sel_hi:[1,0,0]
  v_pk_fma_f32 v[106:107], v[98:99], 0.5, 1.0 op_sel_hi:[1,0,0]
  v_pk_fma_f32 v[108:109], v[100:101], 0.5, 1.0 op_sel_hi:[1,0,0]
  v_pk_fma_f32 v[110:111], v[102:103], 0.5, 1.0 op_sel_hi:[1,0,0]
  v_pk_fma_f32 v[96:97], v[96:97], v[104:105], 1.0 op_sel_hi:[1,1,0]
  v_pk_fma_f32 v[98:99], v[98:99], v[106:107], 1.0 op_sel_hi:[1,1,0]
  v_pk_fma_f32 v[100:101], v[100:101], v[108:109], 1.0 op_sel_hi:[1,1,0]
  v_pk_fma_f32 v[102:103], v[102:103], v[110:111], 1.0 op_sel_hi:[1,1,0]
  v_rcp_f32 v96, v96
  v_rcp_f32 v97, v97
  v_rcp_f32 v98, v98
  v_rcp_f32 v99, v99
  v_rcp_f32 v100, v100
  v_rcp_f32 v101, v101
  v_rcp_f32 v102, v102
  v_rcp_f32 v103, v103
  v_pk_fma_f32 v[96:97], v[48:49], v[96:97], v[48:49] neg_lo:[1,0,0] neg_hi:[1,0,0]
  v_pk_fma_f32 v[98:99], v[50:51], v[98:99], v[50:51] neg_lo:[1,0,0] neg_hi:[1,0,0]
  v_pk_fma_f32 v[100:101], v[52:53], v[100:101], v[52:53] neg_lo:[1,0,0] neg_hi:[1,0,0]
  v_pk_fma_f32 v[102:103], v[54:55], v[102:103], v[54:55] neg_lo:[1,0,0] neg_hi:[1,0,0]
  v_cvt_pk_bf16_f32 v120, v96, v97
  v_cvt_pk_bf16_f32 v121, v98, v99
  v_cvt_pk_bf16_f32 v122, v100, v101
  v_cvt_pk_bf16_f32 v123, v102, v103
  s_add_u32 s62, s101, 32768
  buffer_store_dwordx4 v[120:123], v12, s[44:47], s62 offen sc0 sc1
  v_pk_mul_f32 v[96:97], s[26:27], v[56:57]
  v_pk_mul_f32 v[98:99], s[26:27], v[58:59]
  v_pk_mul_f32 v[100:101], s[26:27], v[60:61]
  v_pk_mul_f32 v[102:103], s[26:27], v[62:63]
  v_exp_f32 v96, v96
  v_exp_f32 v97, v97
  v_exp_f32 v98, v98
  v_exp_f32 v99, v99
  v_exp_f32 v100, v100
  v_exp_f32 v101, v101
  v_exp_f32 v102, v102
  v_exp_f32 v103, v103
  v_pk_fma_f32 v[104:105], v[96:97], 0.5, 1.0 op_sel_hi:[1,0,0]
  v_pk_fma_f32 v[106:107], v[98:99], 0.5, 1.0 op_sel_hi:[1,0,0]
  v_pk_fma_f32 v[108:109], v[100:101], 0.5, 1.0 op_sel_hi:[1,0,0]
  v_pk_fma_f32 v[110:111], v[102:103], 0.5, 1.0 op_sel_hi:[1,0,0]
  v_pk_fma_f32 v[96:97], v[96:97], v[104:105], 1.0 op_sel_hi:[1,1,0]
  v_pk_fma_f32 v[98:99], v[98:99], v[106:107], 1.0 op_sel_hi:[1,1,0]
  v_pk_fma_f32 v[100:101], v[100:101], v[108:109], 1.0 op_sel_hi:[1,1,0]
  v_pk_fma_f32 v[102:103], v[102:103], v[110:111], 1.0 op_sel_hi:[1,1,0]
  v_rcp_f32 v96, v96
  v_rcp_f32 v97, v97
  v_rcp_f32 v98, v98
  v_rcp_f32 v99, v99
  v_rcp_f32 v100, v100
  v_rcp_f32 v101, v101
  v_rcp_f32 v102, v102
  v_rcp_f32 v103, v103
  v_pk_fma_f32 v[96:97], v[56:57], v[96:97], v[56:57] neg_lo:[1,0,0] neg_hi:[1,0,0]
  v_pk_fma_f32 v[98:99], v[58:59], v[98:99], v[58:59] neg_lo:[1,0,0] neg_hi:[1,0,0]
  v_pk_fma_f32 v[100:101], v[60:61], v[100:101], v[60:61] neg_lo:[1,0,0] neg_hi:[1,0,0]
  v_pk_fma_f32 v[102:103], v[62:63], v[102:103], v[62:63] neg_lo:[1,0,0] neg_hi:[1,0,0]
  v_cvt_pk_bf16_f32 v124, v96, v97
  v_cvt_pk_bf16_f32 v125, v98, v99
  v_cvt_pk_bf16_f32 v126, v100, v101
  v_cvt_pk_bf16_f32 v127, v102, v103
  s_add_u32 s62, s101, 33792
  buffer_store_dwordx4 v[124:127], v12, s[44:47], s62 offen sc0 sc1
  s_branch L_cons
L_ffnB:
  s_sub_u32 s65, s52, 4
  s_lshr_b32 s63, s65, 1
  s_add_u32 s92, s85, s63
  s_and_b32 s62, s65, 1
  s_lshl_b32 s96, s65, 12
  s_lshl_b32 s63, s57, 7
  s_mul_i32 s64, s62, 28672
  s_add_u32 s68, s63, s64
  s_mul_i32 s64, s62, 25088
  s_add_u32 s69, s63, s64
  s_lshl_b32 s63, s56, 1
  s_add_u32 s62, s62, s63
  s_mul_i32 s82, s62, 147456
  s_waitcnt vmcnt(0)
  s_barrier
  s_setprio 1
  ds_read_b64_tr_b16 v[64:65], v11 offset:0
  ds_read_b64_tr_b16 v[66:67], v11 offset:512
  ds_read_b64_tr_b16 v[68:69], v11 offset:2048
  ds_read_b64_tr_b16 v[70:71], v11 offset:2560
  ds_read_b64_tr_b16 v[72:73], v11 offset:4096
  ds_read_b64_tr_b16 v[74:75], v11 offset:4608
  ds_read_b64_tr_b16 v[76:77], v11 offset:6144
  ds_read_b64_tr_b16 v[78:79], v11 offset:6656
  v_mov_b32 v116, v14
  s_nop 1
  v_mfma_f32_32x32x16_bf16 v[128:143], v[116:119], v[112:115], 0
  s_waitcnt lgkmcnt(6)
  v_mfma_f32_32x32x16_bf16 v[128:143], v[64:67], a[0:3], v[128:143]
  ds_read_b64_tr_b16 v[80:81], v11 offset:8192
  ds_read_b64_tr_b16 v[82:83], v11 offset:8704
  s_add_u32 m0, s10, 94208
  s_nop 0
  buffer_load_dwordx4 v5, s[32:35], s75 offen lds
  s_waitcnt lgkmcnt(6)
  v_mfma_f32_32x32x16_bf16 v[128:143], v[68:71], a[4:7], v[128:143]
  ds_read_b64_tr_b16 v[84:85], v11 offset:10240
  ds_read_b64_tr_b16 v[86:87], v11 offset:10752
  s_waitcnt lgkmcnt(6)
  v_mfma_f32_32x32x16_bf16 v[128:143], v[72:75], a[8:11], v[128:143]
  ds_read_b64_tr_b16 v[88:89], v11 offset:12288
  ds_read_b64_tr_b16 v[90:91], v11 offset:12800
  s_waitcnt lgkmcnt(6)
  v_mfma_f32_32x32x16_bf16 v[128:143], v[76:79], a[12:15], v[128:143]
  ds_read_b64_tr_b16 v[92:93], v11 offset:14336
  ds_read_b64_tr_b16 v[94:95], v11 offset:14848
  s_waitcnt lgkmcnt(6)
  v_mfma_f32_32x32x16_bf16 v[128:143], v[80:83], a[16:19], v[128:143]
  ds_read_b64_tr_b16 v[64:65], v11 offset:16384
  ds_read_b64_tr_b16 v[66:67], v11 offset:16896
  s_add_u32 m0, s10, 98304
  s_nop 0
  buffer_load_dwordx4 v5, s[32:35], s76 offen lds
  s_waitcnt lgkmcnt(6)
  v_mfma_f32_32x32x16_bf16 v[128:143], v[84:87], a[20:23], v[128:143]
  ds_read_b64_tr_b16 v[68:69], v11 offset:18432
  ds_read_b64_tr_b16 v[70:71], v11 offset:18944
  s_waitcnt lgkmcnt(6)
  v_mfma_f32_32x32x16_bf16 v[128:143], v[88:91], a[24:27], v[128:143]
  ds_read_b64_tr_b16 v[72:73], v11 offset:20480
  ds_read_b64_tr_b16 v[74:75], v11 offset:20992
  s_waitcnt lgkmcnt(6)
  v_mfma_f32_32x32x16_bf16 v[128:143], v[92:95], a[28:31], v[128:143]
  ds_read_b64_tr_b16 v[76:77], v11 offset:22528
  ds_read_b64_tr_b16 v[78:79], v11 offset:23040
  s_waitcnt lgkmcnt(6)
  v_mfma_f32_32x32x16_bf16 v[128:143], v[64:67], a[32:35], v[128:143]
  ds_read_b64_tr_b16 v[80:81], v11 offset:24576
  ds_read_b64_tr_b16 v[82:83], v11 offset:25088
  s_add_u32 m0, s10, 102400
  s_nop 0
  buffer_load_dwordx4 v5, s[32:35], s77 offen lds
  s_waitcnt lgkmcnt(6)
  v_mfma_f32_32x32x16_bf16 v[128:143], v[68:71], a[36:39], v[128:143]
  ds_read_b64_tr_b16 v[84:85], v11 offset:26624
  ds_read_b64_tr_b16 v[86:87], v11 offset:27136
  s_waitcnt lgkmcnt(6)
  v_mfma_f32_32x32x16_bf16 v[128:143], v[72:75], a[40:43], v[128:143]
  ds_read_b64_tr_b16 v[88:89], v11 offset:28672
  ds_read_b64_tr_b16 v[90:91], v11 offset:29184
  s_waitcnt lgkmcnt(6)
  v_mfma_f32_32x32x16_bf16 v[128:143], v[76:79], a[44:47], v[128:143]
  ds_read_b64_tr_b16 v[92:93], v11 offset:30720
  ds_read_b64_tr_b16 v[94:95], v11 offset:31232
  s_waitcnt lgkmcnt(6)
  v_mfma_f32_32x32x16_bf16 v[128:143], v[80:83], a[48:51], v[128:143]
  ds_read_b64_tr_b16 v[64:65], v11 offset:32768
  ds_read_b64_tr_b16 v[66:67], v11 offset:33280
  s_add_u32 m0, s10, 106496
  s_nop 0
  buffer_load_dwordx4 v5, s[32:35], s78 offen lds
  s_waitcnt lgkmcnt(6)
  v_mfma_f32_32x32x16_bf16 v[128:143], v[84:87], a[52:55], v[128:143]
  ds_read_b64_tr_b16 v[68:69], v11 offset:34816
  ds_read_b64_tr_b16 v[70:71], v11 offset:35328
  s_waitcnt lgkmcnt(6)
  v_mfma_f32_32x32x16_bf16 v[128:143], v[88:91], a[56:59], v[128:143]
  ds_read_b64_tr_b16 v[72:73], v11 offset:36864
  ds_read_b64_tr_b16 v[74:75], v11 offset:37376
  s_waitcnt lgkmcnt(6)
  v_mfma_f32_32x32x16_bf16 v[128:143], v[92:95], a[60:63], v[128:143]
  ds_read_b64_tr_b16 v[76:77], v11 offset:38912
  ds_read_b64_tr_b16 v[78:79], v11 offset:39424
  s_waitcnt lgkmcnt(6)
  v_mfma_f32_32x32x16_bf16 v[128:143], v[64:67], a[64:67], v[128:143]
  ds_read_b64_tr_b16 v[80:81], v11 offset:40960
  ds_read_b64_tr_b16 v[82:83], v11 offset:41472
  s_add_u32 m0, s10, 110592
  s_nop 0
  buffer_load_dwordx4 v5, s[32:35], s79 offen lds
  s_waitcnt lgkmcnt(6)
  v_mfma_f32_32x32x16_bf16 v[128:143], v[68:71], a[68:71], v[128:143]
  ds_read_b64_tr_b16 v[84:85], v11 offset:43008
  ds_read_b64_tr_b16 v[86:87], v11 offset:43520
  s_waitcnt lgkmcnt(6)
  v_mfma_f32_32x32x16_bf16 v[128:143], v[72:75], a[72:75], v[128:143]
  ds_read_b64_tr_b16 v[88:89], v11 offset:45056
  ds_read_b64_tr_b16 v[90:91], v11 offset:45568
  s_waitcnt lgkmcnt(6)
  v_mfma_f32_32x32x16_bf16 v[128:143], v[76:79], a[76:79], v[128:143]
  ds_read_b64_tr_b16 v[92:93], v11 offset:47104
  ds_read_b64_tr_b16 v[94:95], v11 offset:47616
  s_waitcnt lgkmcnt(6)
  v_mfma_f32_32x32x16_bf16 v[128:143], v[80:83], a[80:83], v[128:143]
  ds_read_b64_tr_b16 v[64:65], v11 offset:49152
  ds_read_b64_tr_b16 v[66:67], v11 offset:49664
  s_add_u32 m0, s10, 114688
  s_nop 0
  buffer_load_dwordx4 v5, s[32:35], s80 offen lds
  s_waitcnt lgkmcnt(6)
  v_mfma_f32_32x32x16_bf16 v[128:143], v[84:87], a[84:87], v[128:143]
  ds_read_b64_tr_b16 v[68:69], v11 offset:51200
  ds_read_b64_tr_b16 v[70:71], v11 offset:51712
  s_waitcnt lgkmcnt(6)
  v_mfma_f32_32x32x16_bf16 v[128:143], v[88:91], a[88:91], v[128:143]
  ds_read_b64_tr_b16 v[72:73], v11 offset:53248
  ds_read_b64_tr_b16 v[74:75], v11 offset:53760
  s_waitcnt lgkmcnt(6)
  v_mfma_f32_32x32x16_bf16 v[128:143], v[92:95], a[92:95], v[128:143]
  ds_read_b64_tr_b16 v[76:77], v11 offset:55296
  ds_read_b64_tr_b16 v[78:79], v11 offset:55808
  s_waitcnt lgkmcnt(6)
  v_mfma_f32_32x32x16_bf16 v[128:143], v[64:67], a[96:99], v[128:143]
  s_add_u32 m0, s10, 118784
  s_nop 0
  buffer_load_dwordx4 v5, s[32:35], s81 offen lds
  s_waitcnt lgkmcnt(4)
  v_mfma_f32_32x32x16_bf16 v[128:143], v[68:71], a[100:103], v[128:143]
  s_waitcnt lgkmcnt(2)
  v_mfma_f32_32x32x16_bf16 v[128:143], v[72:75], a[104:107], v[128:143]
  s_waitcnt lgkmcnt(0)
  v_mfma_f32_32x32x16_bf16 v[128:143], v[76:79], a[108:111], v[128:143]
  s_setprio 0
  v_mul_f32 v96, s26, v32
  v_mul_f32 v97, s26, v33
  v_mul_f32 v98, s26, v34
  v_mul_f32 v99, s26, v35
  v_mul_f32 v100, s26, v36
  v_mul_f32 v101, s26, v37
  v_mul_f32 v102, s26, v38
  v_mul_f32 v103, s26, v39
  v_exp_f32 v96, v96
  s_add_u32 s64, s92, 0
  s_bfe_u32 s65, s64, 0x20001
  s_and_b32 s64, s64, 1
  s_lshl_b32 s64, s64, 2
  s_mul_i32 s65, s65, 7
  s_add_u32 s64, s64, s65
  s_mul_i32 s88, s64, 57344
  s_add_u32 s88, s88, s68
  s_add_u32 m0, s96, 147456
  s_nop 0
  buffer_load_dwordx4 v18, s[36:39], s88 offen lds
  v_exp_f32 v97, v97
  v_exp_f32 v98, v98
  v_exp_f32 v99, v99
  v_exp_f32 v100, v100
  v_exp_f32 v101, v101
  v_exp_f32 v102, v102
  v_exp_f32 v103, v103
  v_fma_f32 v104, v96, 0.5, 1.0
  v_fma_f32 v105, v97, 0.5, 1.0
  buffer_load_dwordx4 v19, s[36:39], s88 offen offset:1024 lds
  v_fma_f32 v106, v98, 0.5, 1.0
  v_fma_f32 v107, v99, 0.5, 1.0
  v_fma_f32 v108, v100, 0.5, 1.0
  v_fma_f32 v109, v101, 0.5, 1.0
  v_fma_f32 v110, v102, 0.5, 1.0
  v_fma_f32 v111, v103, 0.5, 1.0
  v_fma_f32 v96, v96, v104, 1.0
  v_fma_f32 v97, v97, v105, 1.0
  v_fma_f32 v98, v98, v106, 1.0
  v_fma_f32 v99, v99, v107, 1.0
  v_fma_f32 v100, v100, v108, 1.0
  v_fma_f32 v101, v101, v109, 1.0
  v_fma_f32 v102, v102, v110, 1.0
  v_fma_f32 v103, v103, v111, 1.0
  v_rcp_f32 v96, v96
  v_rcp_f32 v97, v97
  buffer_load_dwordx4 v20, s[36:39], s88 offen offset:2048 lds
  v_rcp_f32 v98, v98
  v_rcp_f32 v99, v99
  v_rcp_f32 v100, v100
  v_rcp_f32 v101, v101
  v_rcp_f32 v102, v102
  v_rcp_f32 v103, v103
  v_fma_f32 v96, -v32, v96, v32
  v_fma_f32 v97, -v33, v97, v33
  v_fma_f32 v98, -v34, v98, v34
  v_fma_f32 v99, -v35, v99, v35
  v_fma_f32 v100, -v36, v100, v36
  buffer_load_dwordx4 v21, s[36:39], s88 offen offset:3072 lds
  v_fma_f32 v101, -v37, v101, v37
  v_fma_f32 v102, -v38, v102, v38
  v_fma_f32 v103, -v39, v103, v39
  v_cvt_pk_bf16_f32 v120, v96, v97
  v_cvt_pk_bf16_f32 v121, v98, v99
  v_cvt_pk_bf16_f32 v122, v100, v101
  v_cvt_pk_bf16_f32 v123, v102, v103
  s_add_u32 s62, s100, 32768
  buffer_store_dwordx4 v[120:123], v12, s[44:47], s62 offen sc0 sc1
  v_mul_f32 v96, s26, v40
  v_mul_f32 v97, s26, v41
  v_mul_f32 v98, s26, v42
  v_mul_f32 v99, s26, v43
  v_mul_f32 v100, s26, v44
  v_mul_f32 v101, s26, v45
  v_mul_f32 v102, s26, v46
  v_mul_f32 v103, s26, v47
  v_exp_f32 v96, v96
  s_add_u32 s64, s92, 2
  s_bfe_u32 s65, s64, 0x20001
  s_and_b32 s64, s64, 1
  s_lshl_b32 s64, s64, 2
  s_mul_i32 s65, s65, 7
  s_add_u32 s64, s64, s65
  s_mul_i32 s88, s64, 57344
  s_add_u32 s88, s88, s68
  s_add_u32 m0, s96, 131072
  s_nop 0
  buffer_load_dwordx4 v18, s[36:39], s88 offen lds
  v_exp_f32 v97, v97
  v_exp_f32 v98, v98
  v_exp_f32 v99, v99
  v_exp_f32 v100, v100
  v_exp_f32 v101, v101
  v_exp_f32 v102, v102
  v_exp_f32 v103, v103
  v_fma_f32 v104, v96, 0.5, 1.0
  v_fma_f32 v105, v97, 0.5, 1.0
  buffer_load_dwordx4 v19, s[36:39], s88 offen offset:1024 lds
  v_fma_f32 v106, v98, 0.5, 1.0
  v_fma_f32 v107, v99, 0.5, 1.0
  v_fma_f32 v108, v100, 0.5, 1.0
  v_fma_f32 v109, v101, 0.5, 1.0
  v_fma_f32 v110, v102, 0.5, 1.0
  v_fma_f32 v111, v103, 0.5, 1.0
  v_fma_f32 v96, v96, v104, 1.0
  v_fma_f32 v97, v97, v105, 1.0
  v_fma_f32 v98, v98, v106, 1.0
  v_fma_f32 v99, v99, v107, 1.0
  v_fma_f32 v100, v100, v108, 1.0
  v_fma_f32 v101, v101, v109, 1.0
  v_fma_f32 v102, v102, v110, 1.0
  v_fma_f32 v103, v103, v111, 1.0
  v_rcp_f32 v96, v96
  v_rcp_f32 v97, v97
  buffer_load_dwordx4 v20, s[36:39], s88 offen offset:2048 lds
  v_rcp_f32 v98, v98
  v_rcp_f32 v99, v99
  v_rcp_f32 v100, v100
  v_rcp_f32 v101, v101
  v_rcp_f32 v102, v102
  v_rcp_f32 v103, v103
  v_fma_f32 v96, -v40, v96, v40
  v_fma_f32 v97, -v41, v97, v41
  v_fma_f32 v98, -v42, v98, v42
  v_fma_f32 v99, -v43, v99, v43
  v_fma_f32 v100, -v44, v100, v44
  buffer_load_dwordx4 v21, s[36:39], s88 offen offset:3072 lds
  v_fma_f32 v101, -v45, v101, v45
  v_fma_f32 v102, -v46, v102, v46
  v_fma_f32 v103, -v47, v103, v47
  v_cvt_pk_bf16_f32 v124, v96, v97
  v_cvt_pk_bf16_f32 v125, v98, v99
  v_cvt_pk_bf16_f32 v126, v100, v101
  v_cvt_pk_bf16_f32 v127, v102, v103
  s_add_u32 s62, s100, 33792
  buffer_store_dwordx4 v[124:127], v12, s[44:47], s62 offen sc0 sc1
  s_waitcnt vmcnt(10)
  s_barrier
  v_mul_f32 v96, s26, v48
  v_mul_f32 v97, s26, v49
  v_mul_f32 v98, s26, v50
  v_mul_f32 v99, s26, v51
  v_mul_f32 v100, s26, v52
  v_mul_f32 v101, s26, v53
  v_mul_f32 v102, s26, v54
  v_mul_f32 v103, s26, v55
  s_add_u32 s64, s92, 4
  s_bfe_u32 s65, s64, 0x20001
  s_and_b32 s64, s64, 1
  s_lshl_b32 s64, s64, 2
  s_mul_i32 s65, s65, 7
  s_add_u32 s64, s64, s65
  s_mul_i32 s88, s64, 57344
  s_add_u32 s88, s88, s68
  s_add_u32 m0, s96, 81920
  s_nop 0
  buffer_load_dwordx4 v18, s[36:39], s88 offen lds
  v_exp_f32 v96, v96
  v_exp_f32 v97, v97
  v_exp_f32 v98, v98
  v_exp_f32 v99, v99
  v_exp_f32 v100, v100
  v_exp_f32 v101, v101
  v_exp_f32 v102, v102
  v_exp_f32 v103, v103
  buffer_load_dwordx4 v19, s[36:39], s88 offen offset:1024 lds
  v_fma_f32 v104, v96, 0.5, 1.0
  v_fma_f32 v105, v97, 0.5, 1.0
  v_fma_f32 v106, v98, 0.5, 1.0
  v_fma_f32 v107, v99, 0.5, 1.0
  v_fma_f32 v108, v100, 0.5, 1.0
  v_fma_f32 v109, v101, 0.5, 1.0
  v_fma_f32 v110, v102, 0.5, 1.0
  v_fma_f32 v111, v103, 0.5, 1.0
  v_fma_f32 v96, v96, v104, 1.0
  v_fma_f32 v97, v97, v105, 1.0
  v_fma_f32 v98, v98, v106, 1.0
  v_fma_f32 v99, v99, v107, 1.0
  v_fma_f32 v100, v100, v108, 1.0
  v_fma_f32 v101, v101, v109, 1.0
  v_fma_f32 v102, v102, v110, 1.0
  buffer_load_dwordx4 v20, s[36:39], s88 offen offset:2048 lds
  v_fma_f32 v103, v103, v111, 1.0
  v_rcp_f32 v96, v96
  v_rcp_f32 v97, v97
  v_rcp_f32 v98, v98
  v_rcp_f32 v99, v99
  v_rcp_f32 v100, v100
  v_rcp_f32 v101, v101
  v_rcp_f32 v102, v102
  buffer_load_dwordx4 v21, s[36:39], s88 offen offset:3072 lds
  v_rcp_f32 v103, v103
  v_fma_f32 v96, -v48, v96, v48
  v_fma_f32 v97, -v49, v97, v49
  v_fma_f32 v98, -v50, v98, v50
  v_fma_f32 v99, -v51, v99, v51
  v_fma_f32 v100, -v52, v100, v52
  v_fma_f32 v101, -v53, v101, v53
  v_fma_f32 v102, -v54, v102, v54
  v_fma_f32 v103, -v55, v103, v55
  v_cvt_pk_bf16_f32 v120, v96, v97
  v_cvt_pk_bf16_f32 v121, v98, v99
  v_cvt_pk_bf16_f32 v122, v100, v101
  v_cvt_pk_bf16_f32 v123, v102, v103
  s_add_u32 s62, s100, 34816
  buffer_store_dwordx4 v[120:123], v12, s[44:47], s62 offen sc0 sc1
  buffer_load_dwordx2 v[16:17], v13, s[44:47], s83 offen offset:0 sc1
  v_mul_f32 v96, s26, v56
  v_mul_f32 v97, s26, v57
  v_mul_f32 v98, s26, v58
  v_mul_f32 v99, s26, v59
  v_mul_f32 v100, s26, v60
  v_mul_f32 v101, s26, v61
  v_mul_f32 v102, s26, v62
  v_mul_f32 v103, s26, v63
  v_exp_f32 v96, v96
  v_exp_f32 v97, v97
  v_exp_f32 v98, v98
  v_exp_f32 v99, v99
  s_add_u32 s64, s92, 6
  s_bfe_u32 s65, s64, 0x20001
  s_and_b32 s64, s64, 1
  s_lshl_b32 s64, s64, 2
  s_mul_i32 s65, s65, 7
  s_add_u32 s64, s64, s65
  s_mul_i32 s88, s64, 57344
  s_add_u32 s88, s88, s68
  s_add_u32 m0, s96, 65536
  s_nop 0
  buffer_load_dwordx4 v18, s[36:39], s88 offen lds
  v_exp_f32 v100, v100
  v_exp_f32 v101, v101
  v_exp_f32 v102, v102
  v_exp_f32 v103, v103
  v_fma_f32 v104, v96, 0.5, 1.0
  v_fma_f32 v105, v97, 0.5, 1.0
  v_fma_f32 v106, v98, 0.5, 1.0
  v_fma_f32 v107, v99, 0.5, 1.0
  v_fma_f32 v108, v100, 0.5, 1.0
  v_fma_f32 v109, v101, 0.5, 1.0
  v_fma_f32 v110, v102, 0.5, 1.0
  buffer_load_dwordx4 v19, s[36:39], s88 offen offset:1024 lds
  v_fma_f32 v111, v103, 0.5, 1.0
  v_fma_f32 v96, v96, v104, 1.0
  v_fma_f32 v97, v97, v105, 1.0
  v_fma_f32 v98, v98, v106, 1.0
  v_fma_f32 v99, v99, v107, 1.0
  v_fma_f32 v100, v100, v108, 1.0
  v_fma_f32 v101, v101, v109, 1.0
  v_fma_f32 v102, v102, v110, 1.0
  v_fma_f32 v103, v103, v111, 1.0
  v_rcp_f32 v96, v96
  v_rcp_f32 v97, v97
  v_rcp_f32 v98, v98
  buffer_load_dwordx4 v20, s[36:39], s88 offen offset:2048 lds
  v_rcp_f32 v99, v99
  v_rcp_f32 v100, v100
  v_rcp_f32 v101, v101
  v_rcp_f32 v102, v102
  v_rcp_f32 v103, v103
  v_fma_f32 v96, -v56, v96, v56
  v_fma_f32 v97, -v57, v97, v57
  v_fma_f32 v98, -v58, v98, v58
  v_fma_f32 v99, -v59, v99, v59
  v_fma_f32 v100, -v60, v100, v60
  v_fma_f32 v101, -v61, v101, v61
  buffer_load_dwordx4 v21, s[36:39], s88 offen offset:3072 lds
  v_fma_f32 v102, -v62, v102, v62
  v_fma_f32 v103, -v63, v103, v63
  v_cvt_pk_bf16_f32 v124, v96, v97
  v_cvt_pk_bf16_f32 v125, v98, v99
  v_cvt_pk_bf16_f32 v126, v100, v101
  v_cvt_pk_bf16_f32 v127, v102, v103
  s_add_u32 s62, s100, 35840
  buffer_store_dwordx4 v[124:127], v12, s[44:47], s62 offen sc0 sc1
  s_barrier
  s_waitcnt vmcnt(5)
  v_cmp_eq_u64 vcc, s[60:61], v[16:17]
  s_and_b32 s64, vcc_lo, 65280
  s_cmp_eq_u32 s64, 65280
  s_cbranch_scc0 L_late_6
  s_add_u32 s64, s92, 0
  s_bfe_u32 s65, s64, 0x20001
  s_and_b32 s64, s64, 1
  s_lshl_b32 s64, s64, 2
  s_mul_i32 s65, s65, 7
  s_add_u32 s64, s64, s65
  s_lshl_b32 s62, s64, 12
  s_add_u32 s62, s62, 32768
  s_add_u32 s62, s62, s82
  s_add_u32 m0, s96, 0
  s_nop 0
  buffer_load_dwordx4 v12, s[44:47], s62 offen sc1 lds
  buffer_load_dwordx4 v12, s[44:47], s62 offen offset:1024 sc1 lds
  buffer_load_dwordx4 v12, s[44:47], s62 offen offset:2048 sc1 lds
  buffer_load_dwordx4 v12, s[44:47], s62 offen offset:3072 sc1 lds
  s_add_u32 s64, s92, 2
  s_bfe_u32 s65, s64, 0x20001
  s_and_b32 s64, s64, 1
  s_lshl_b32 s64, s64, 2
  s_mul_i32 s65, s65, 7
  s_add_u32 s64, s64, s65
  s_lshl_b32 s62, s64, 12
  s_add_u32 s62, s62, 32768
  s_add_u32 s62, s62, s82
  s_add_u32 m0, s96, 16384
  s_nop 0
  buffer_load_dwordx4 v12, s[44:47], s62 offen sc1 lds
  buffer_load_dwordx4 v12, s[44:47], s62 offen offset:1024 sc1 lds
  buffer_load_dwordx4 v12, s[44:47], s62 offen offset:2048 sc1 lds
  buffer_load_dwordx4 v12, s[44:47], s62 offen offset:3072 sc1 lds
  s_add_u32 s64, s92, 4
  s_bfe_u32 s65, s64, 0x20001
  s_and_b32 s64, s64, 1
  s_lshl_b32 s64, s64, 2
  s_mul_i32 s65, s65, 7
  s_add_u32 s64, s64, s65
  s_lshl_b32 s62, s64, 12
  s_add_u32 s62, s62, 32768
  s_add_u32 s62, s62, s82
  s_add_u32 m0, s96, 32768
  s_nop 0
  buffer_load_dwordx4 v12, s[44:47], s62 offen sc1 lds
  buffer_load_dwordx4 v12, s[44:47], s62 offen offset:1024 sc1 lds
  buffer_load_dwordx4 v12, s[44:47], s62 offen offset:2048 sc1 lds
  buffer_load_dwordx4 v12, s[44:47], s62 offen offset:3072 sc1 lds
  v_pk_mul_f32 v[96:97], s[26:27], v[128:129]
  v_pk_mul_f32 v[98:99], s[26:27], v[130:131]
  v_pk_mul_f32 v[100:101], s[26:27], v[132:133]
  v_pk_mul_f32 v[102:103], s[26:27], v[134:135]
  v_exp_f32 v96, v96
  v_exp_f32 v97, v97
  v_exp_f32 v98, v98
  v_exp_f32 v99, v99
  v_exp_f32 v100, v100
  v_exp_f32 v101, v101
  v_exp_f32 v102, v102
  v_exp_f32 v103, v103
  v_pk_fma_f32 v[104:105], v[96:97], 0.5, 1.0 op_sel_hi:[1,0,0]
  v_pk_fma_f32 v[106:107], v[98:99], 0.5, 1.0 op_sel_hi:[1,0,0]
  v_pk_fma_f32 v[108:109], v[100:101], 0.5, 1.0 op_sel_hi:[1,0,0]
  v_pk_fma_f32 v[110:111], v[102:103], 0.5, 1.0 op_sel_hi:[1,0,0]
  v_pk_fma_f32 v[96:97], v[96:97], v[104:105], 1.0 op_sel_hi:[1,1,0]
  v_pk_fma_f32 v[98:99], v[98:99], v[106:107], 1.0 op_sel_hi:[1,1,0]
  v_pk_fma_f32 v[100:101], v[100:101], v[108:109], 1.0 op_sel_hi:[1,1,0]
  v_pk_fma_f32 v[102:103], v[102:103], v[110:111], 1.0 op_sel_hi:[1,1,0]
  v_rcp_f32 v96, v96
  v_rcp_f32 v97, v97
  v_rcp_f32 v98, v98
  v_rcp_f32 v99, v99
  v_rcp_f32 v100, v100
  v_rcp_f32 v101, v101
  v_rcp_f32 v102, v102
  v_rcp_f32 v103, v103
  v_pk_fma_f32 v[96:97], v[128:129], v[96:97], v[128:129] neg_lo:[1,0,0] neg_hi:[1,0,0]
  v_pk_fma_f32 v[98:99], v[130:131], v[98:99], v[130:131] neg_lo:[1,0,0] neg_hi:[1,0,0]
  v_pk_fma_f32 v[100:101], v[132:133], v[100:101], v[132:133] neg_lo:[1,0,0] neg_hi:[1,0,0]
  v_pk_fma_f32 v[102:103], v[134:135], v[102:103], v[134:135] neg_lo:[1,0,0] neg_hi:[1,0,0]
  v_cvt_pk_bf16_f32 v120, v96, v97
  v_cvt_pk_bf16_f32 v121, v98, v99
  v_cvt_pk_bf16_f32 v122, v100, v101
  v_cvt_pk_bf16_f32 v123, v102, v103
  s_add_u32 s62, s97, 32768
  buffer_store_dwordx4 v[120:123], v12, s[44:47], s62 offen sc0 sc1
  v_pk_mul_f32 v[96:97], s[26:27], v[136:137]
  v_pk_mul_f32 v[98:99], s[26:27], v[138:139]
  v_pk_mul_f32 v[100:101], s[26:27], v[140:141]
  v_pk_mul_f32 v[102:103], s[26:27], v[142:143]
  v_exp_f32 v96, v96
  v_exp_f32 v97, v97
  v_exp_f32 v98, v98
  v_exp_f32 v99, v99
  v_exp_f32 v100, v100
  v_exp_f32 v101, v101
  v_exp_f32 v102, v102
  v_exp_f32 v103, v103
  v_pk_fma_f32 v[104:105], v[96:97], 0.5, 1.0 op_sel_hi:[1,0,0]
  v_pk_fma_f32 v[106:107], v[98:99], 0.5, 1.0 op_sel_hi:[1,0,0]
  s_waitcnt vmcnt(13)
  v_mov_b32 v24, 1
  s_mov_b64 exec, 1
  ds_add_rtn_u32 v25, v22, v24 offset:57348
  s_mov_b64 exec, -1
  v_pk_fma_f32 v[108:109], v[100:101], 0.5, 1.0 op_sel_hi:[1,0,0]
  v_pk_fma_f32 v[110:111], v[102:103], 0.5, 1.0 op_sel_hi:[1,0,0]
  v_pk_fma_f32 v[96:97], v[96:97], v[104:105], 1.0 op_sel_hi:[1,1,0]
  v_pk_fma_f32 v[98:99], v[98:99], v[106:107], 1.0 op_sel_hi:[1,1,0]
  v_pk_fma_f32 v[100:101], v[100:101], v[108:109], 1.0 op_sel_hi:[1,1,0]
  v_pk_fma_f32 v[102:103], v[102:103], v[110:111], 1.0 op_sel_hi:[1,1,0]
  v_rcp_f32 v96, v96
  v_rcp_f32 v97, v97
  v_rcp_f32 v98, v98
  v_rcp_f32 v99, v99
  v_rcp_f32 v100, v100
  v_rcp_f32 v101, v101
  v_rcp_f32 v102, v102
  v_rcp_f32 v103, v103
  s_waitcnt lgkmcnt(0)
  v_readfirstlane_b32 s62, v25
  s_nop 3
  s_cmp_lg_u32 s62, 3
  s_cbranch_scc1 L_skip_8
  s_lshl_b32 s62, s53, 9
  s_lshl_b32 s63, s58, 3
  s_add_u32 s62, s62, s63
  s_add_u32 s62, s62, 16853120
  v_mov_b32 v24, s60
  v_mov_b32 v25, s61
  s_mov_b64 exec, 1
  buffer_store_dwordx2 v[24:25], v22, s[44:47], s62 offen sc0 sc1
  s_mov_b64 exec, -1
L_skip_8:
  v_pk_fma_f32 v[96:97], v[136:137], v[96:97], v[136:137] neg_lo:[1,0,0] neg_hi:[1,0,0]
  v_pk_fma_f32 v[98:99], v[138:139], v[98:99], v[138:139] neg_lo:[1,0,0] neg_hi:[1,0,0]
  v_pk_fma_f32 v[100:101], v[140:141], v[100:101], v[140:141] neg_lo:[1,0,0] neg_hi:[1,0,0]
  v_pk_fma_f32 v[102:103], v[142:143], v[102:103], v[142:143] neg_lo:[1,0,0] neg_hi:[1,0,0]
  v_cvt_pk_bf16_f32 v124, v96, v97
  v_cvt_pk_bf16_f32 v125, v98, v99
  v_cvt_pk_bf16_f32 v126, v100, v101
  v_cvt_pk_bf16_f32 v127, v102, v103
  s_add_u32 s62, s97, 33792
  buffer_store_dwordx4 v[124:127], v12, s[44:47], s62 offen sc0 sc1
  s_waitcnt vmcnt(10)
  s_branch L_j_7
L_late_6:
  buffer_load_dwordx2 v[16:17], v13, s[44:47], s83 offen offset:0 sc1
  v_pk_mul_f32 v[96:97], s[26:27], v[128:129]
  v_pk_mul_f32 v[98:99], s[26:27], v[130:131]
  v_pk_mul_f32 v[100:101], s[26:27], v[132:133]
  v_pk_mul_f32 v[102:103], s[26:27], v[134:135]
  v_exp_f32 v96, v96
  v_exp_f32 v97, v97
  v_exp_f32 v98, v98
  v_exp_f32 v99, v99
  v_exp_f32 v100, v100
  v_exp_f32 v101, v101
  v_exp_f32 v102, v102
  v_exp_f32 v103, v103
  v_pk_fma_f32 v[104:105], v[96:97], 0.5, 1.0 op_sel_hi:[1,0,0]
  v_pk_fma_f32 v[106:107], v[98:99], 0.5, 1.0 op_sel_hi:[1,0,0]
  v_pk_fma_f32 v[108:109], v[100:101], 0.5, 1.0 op_sel_hi:[1,0,0]
  v_pk_fma_f32 v[110:111], v[102:103], 0.5, 1.0 op_sel_hi:[1,0,0]
  v_pk_fma_f32 v[96:97], v[96:97], v[104:105], 1.0 op_sel_hi:[1,1,0]
  v_pk_fma_f32 v[98:99], v[98:99], v[106:107], 1.0 op_sel_hi:[1,1,0]
  v_pk_fma_f32 v[100:101], v[100:101], v[108:109], 1.0 op_sel_hi:[1,1,0]
  v_pk_fma_f32 v[102:103], v[102:103], v[110:111], 1.0 op_sel_hi:[1,1,0]
  v_rcp_f32 v96, v96
  v_rcp_f32 v97, v97
  v_rcp_f32 v98, v98
  v_rcp_f32 v99, v99
  v_rcp_f32 v100, v100
  v_rcp_f32 v101, v101
  v_rcp_f32 v102, v102
  v_rcp_f32 v103, v103
  v_pk_fma_f32 v[96:97], v[128:129], v[96:97], v[128:129] neg_lo:[1,0,0] neg_hi:[1,0,0]
  v_pk_fma_f32 v[98:99], v[130:131], v[98:99], v[130:131] neg_lo:[1,0,0] neg_hi:[1,0,0]
  v_pk_fma_f32 v[100:101], v[132:133], v[100:101], v[132:133] neg_lo:[1,0,0] neg_hi:[1,0,0]
  v_pk_fma_f32 v[102:103], v[134:135], v[102:103], v[134:135] neg_lo:[1,0,0] neg_hi:[1,0,0]
  v_cvt_pk_bf16_f32 v120, v96, v97
  v_cvt_pk_bf16_f32 v121, v98, v99
  v_cvt_pk_bf16_f32 v122, v100, v101
  v_cvt_pk_bf16_f32 v123, v102, v103
  s_add_u32 s62, s97, 32768
  buffer_store_dwordx4 v[120:123], v12, s[44:47], s62 offen sc0 sc1
  v_pk_mul_f32 v[96:97], s[26:27], v[136:137]
  v_pk_mul_f32 v[98:99], s[26:27], v[138:139]
  v_pk_mul_f32 v[100:101], s[26:27], v[140:141]
  v_pk_mul_f32 v[102:103], s[26:27], v[142:143]
  v_exp_f32 v96, v96
  v_exp_f32 v97, v97
  v_exp_f32 v98, v98
  v_exp_f32 v99, v99
  v_exp_f32 v100, v100
  v_exp_f32 v101, v101
  v_exp_f32 v102, v102
  v_exp_f32 v103, v103
  v_pk_fma_f32 v[104:105], v[96:97], 0.5, 1.0 op_sel_hi:[1,0,0]
  v_pk_fma_f32 v[106:107], v[98:99], 0.5, 1.0 op_sel_hi:[1,0,0]
  s_waitcnt vmcnt(2)
  v_mov_b32 v24, 1
  s_mov_b64 exec, 1
  ds_add_rtn_u32 v25, v22, v24 offset:57348
  s_mov_b64 exec, -1
  v_pk_fma_f32 v[108:109], v[100:101], 0.5, 1.0 op_sel_hi:[1,0,0]
  v_pk_fma_f32 v[110:111], v[102:103], 0.5, 1.0 op_sel_hi:[1,0,0]
  v_pk_fma_f32 v[96:97], v[96:97], v[104:105], 1.0 op_sel_hi:[1,1,0]
  v_pk_fma_f32 v[98:99], v[98:99], v[106:107], 1.0 op_sel_hi:[1,1,0]
  v_pk_fma_f32 v[100:101], v[100:101], v[108:109], 1.0 op_sel_hi:[1,1,0]
  v_pk_fma_f32 v[102:103], v[102:103], v[110:111], 1.0 op_sel_hi:[1,1,0]
  v_rcp_f32 v96, v96
  v_rcp_f32 v97, v97
  v_rcp_f32 v98, v98
  v_rcp_f32 v99, v99
  v_rcp_f32 v100, v100
  v_rcp_f32 v101, v101
  v_rcp_f32 v102, v102
  v_rcp_f32 v103, v103
  s_waitcnt lgkmcnt(0)
  v_readfirstlane_b32 s62, v25
  s_nop 3
  s_cmp_lg_u32 s62, 3
  s_cbranch_scc1 L_skip_9
  s_lshl_b32 s62, s53, 9
  s_lshl_b32 s63, s58, 3
  s_add_u32 s62, s62, s63
  s_add_u32 s62, s62, 16853120
  v_mov_b32 v24, s60
  v_mov_b32 v25, s61
  s_mov_b64 exec, 1
  buffer_store_dwordx2 v[24:25], v22, s[44:47], s62 offen sc0 sc1
  s_mov_b64 exec, -1
L_skip_9:
  v_pk_fma_f32 v[96:97], v[136:137], v[96:97], v[136:137] neg_lo:[1,0,0] neg_hi:[1,0,0]
  v_pk_fma_f32 v[98:99], v[138:139], v[98:99], v[138:139] neg_lo:[1,0,0] neg_hi:[1,0,0]
  v_pk_fma_f32 v[100:101], v[140:141], v[100:101], v[140:141] neg_lo:[1,0,0] neg_hi:[1,0,0]
  v_pk_fma_f32 v[102:103], v[142:143], v[102:103], v[142:143] neg_lo:[1,0,0] neg_hi:[1,0,0]
  v_cvt_pk_bf16_f32 v124, v96, v97
  v_cvt_pk_bf16_f32 v125, v98, v99
  v_cvt_pk_bf16_f32 v126, v100, v101
  v_cvt_pk_bf16_f32 v127, v102, v103
  s_add_u32 s62, s97, 33792
  buffer_store_dwordx4 v[124:127], v12, s[44:47], s62 offen sc0 sc1
  s_waitcnt vmcnt(2)
  s_mov_b32 s84, 65536
  s_branch L_pchk_12
L_poll_10:
  s_sleep 1
  buffer_load_dwordx2 v[16:17], v13, s[44:47], s83 offen offset:0 sc1
  s_waitcnt vmcnt(0)
L_pchk_12:
  v_cmp_eq_u64 vcc, s[60:61], v[16:17]
  s_and_b32 s64, vcc_lo, 65280
  s_cmp_eq_u32 s64, 65280
  s_cbranch_scc1 L_pok_11
  s_sub_u32 s84, s84, 1
  s_cmp_lg_u32 s84, 0
  s_cbranch_scc1 L_poll_10
L_pok_11:
  s_add_u32 s64, s92, 0
  s_bfe_u32 s65, s64, 0x20001
  s_and_b32 s64, s64, 1
  s_lshl_b32 s64, s64, 2
  s_mul_i32 s65, s65, 7
  s_add_u32 s64, s64, s65
  s_lshl_b32 s62, s64, 12
  s_add_u32 s62, s62, 32768
  s_add_u32 s62, s62, s82
  s_add_u32 m0, s96, 0
  s_nop 0
  buffer_load_dwordx4 v12, s[44:47], s62 offen sc1 lds
  buffer_load_dwordx4 v12, s[44:47], s62 offen offset:1024 sc1 lds
  buffer_load_dwordx4 v12, s[44:47], s62 offen offset:2048 sc1 lds
  buffer_load_dwordx4 v12, s[44:47], s62 offen offset:3072 sc1 lds
  s_add_u32 s64, s92, 2
  s_bfe_u32 s65, s64, 0x20001
  s_and_b32 s64, s64, 1
  s_lshl_b32 s64, s64, 2
  s_mul_i32 s65, s65, 7
  s_add_u32 s64, s64, s65
  s_lshl_b32 s62, s64, 12
  s_add_u32 s62, s62, 32768
  s_add_u32 s62, s62, s82
  s_add_u32 m0, s96, 16384
  s_nop 0
  buffer_load_dwordx4 v12, s[44:47], s62 offen sc1 lds
  buffer_load_dwordx4 v12, s[44:47], s62 offen offset:1024 sc1 lds
  buffer_load_dwordx4 v12, s[44:47], s62 offen offset:2048 sc1 lds
  buffer_load_dwordx4 v12, s[44:47], s62 offen offset:3072 sc1 lds
  s_add_u32 s64, s92, 4
  s_bfe_u32 s65, s64, 0x20001
  s_and_b32 s64, s64, 1
  s_lshl_b32 s64, s64, 2
  s_mul_i32 s65, s65, 7
  s_add_u32 s64, s64, s65
  s_lshl_b32 s62, s64, 12
  s_add_u32 s62, s62, 32768
  s_add_u32 s62, s62, s82
  s_add_u32 m0, s96, 32768
  s_nop 0
  buffer_load_dwordx4 v12, s[44:47], s62 offen sc1 lds
  buffer_load_dwordx4 v12, s[44:47], s62 offen offset:1024 sc1 lds
  buffer_load_dwordx4 v12, s[44:47], s62 offen offset:2048 sc1 lds
  buffer_load_dwordx4 v12, s[44:47], s62 offen offset:3072 sc1 lds
  s_waitcnt vmcnt(8)
L_j_7:
  s_barrier
  s_add_u32 s64, s92, 0
  s_bfe_u32 s65, s64, 0x20001
  s_and_b32 s64, s64, 1
  s_lshl_b32 s64, s64, 2
  s_mul_i32 s65, s65, 7
  s_add_u32 s64, s64, s65
  s_add_u32 s64, s64, 1
  s_mul_i32 s62, s64, 57344
  s_add_u32 s62, s62, s68
  s_add_u32 m0, s96, 114688
  s_nop 0
  buffer_load_dwordx4 v18, s[36:39], s62 offen lds
  buffer_load_dwordx4 v19, s[36:39], s62 offen offset:1024 lds
  buffer_load_dwordx4 v20, s[36:39], s62 offen offset:2048 lds
  buffer_load_dwordx4 v21, s[36:39], s62 offen offset:3072 lds
  s_add_u32 s64, s92, 2
  s_bfe_u32 s65, s64, 0x20001
  s_and_b32 s64, s64, 1
  s_lshl_b32 s64, s64, 2
  s_mul_i32 s65, s65, 7
  s_add_u32 s64, s64, s65
  s_add_u32 s64, s64, 1
  s_mul_i32 s62, s64, 57344
  s_add_u32 s62, s62, s68
  s_add_u32 m0, s96, 98304
  s_nop 0
  buffer_load_dwordx4 v18, s[36:39], s62 offen lds
  buffer_load_dwordx4 v19, s[36:39], s62 offen offset:1024 lds
  buffer_load_dwordx4 v20, s[36:39], s62 offen offset:2048 lds
  buffer_load_dwordx4 v21, s[36:39], s62 offen offset:3072 lds
  s_waitcnt vmcnt(12)
  s_barrier
  s_add_u32 s64, s92, 6
  s_bfe_u32 s65, s64, 0x20001
  s_and_b32 s64, s64, 1
  s_lshl_b32 s64, s64, 2
  s_mul_i32 s65, s65, 7
  s_add_u32 s64, s64, s65
  s_lshl_b32 s62, s64, 12
  s_add_u32 s62, s62, 32768
  s_add_u32 s62, s62, s82
  s_add_u32 m0, s96, 0
  s_nop 0
  buffer_load_dwordx4 v12, s[44:47], s62 offen sc1 lds
  buffer_load_dwordx4 v12, s[44:47], s62 offen offset:1024 sc1 lds
  buffer_load_dwordx4 v12, s[44:47], s62 offen offset:2048 sc1 lds
  buffer_load_dwordx4 v12, s[44:47], s62 offen offset:3072 sc1 lds
  s_add_u32 s64, s92, 4
  s_bfe_u32 s65, s64, 0x20001
  s_and_b32 s64, s64, 1
  s_lshl_b32 s64, s64, 2
  s_mul_i32 s65, s65, 7
  s_add_u32 s64, s64, s65
  s_add_u32 s64, s64, 1
  s_mul_i32 s62, s64, 57344
  s_add_u32 s62, s62, s68
  s_add_u32 m0, s96, 147456
  s_nop 0
  buffer_load_dwordx4 v18, s[36:39], s62 offen lds
  buffer_load_dwordx4 v19, s[36:39], s62 offen offset:1024 lds
  buffer_load_dwordx4 v20, s[36:39], s62 offen offset:2048 lds
  buffer_load_dwordx4 v21, s[36:39], s62 offen offset:3072 lds
  s_waitcnt vmcnt(16)
  s_barrier
  s_add_u32 s64, s92, 0
  s_bfe_u32 s65, s64, 0x20001
  s_and_b32 s64, s64, 1
  s_lshl_b32 s64, s64, 2
  s_mul_i32 s65, s65, 7
  s_add_u32 s64, s64, s65
  s_add_u32 s64, s64, 1
  s_lshl_b32 s62, s64, 12
  s_add_u32 s62, s62, 32768
  s_add_u32 s62, s62, s82
  s_add_u32 m0, s96, 16384
  s_nop 0
  buffer_load_dwordx4 v12, s[44:47], s62 offen sc1 lds
  buffer_load_dwordx4 v12, s[44:47], s62 offen offset:1024 sc1 lds
  buffer_load_dwordx4 v12, s[44:47], s62 offen offset:2048 sc1 lds
  buffer_load_dwordx4 v12, s[44:47], s62 offen offset:3072 sc1 lds
  s_add_u32 s64, s92, 6
  s_bfe_u32 s65, s64, 0x20001
  s_and_b32 s64, s64, 1
  s_lshl_b32 s64, s64, 2
  s_mul_i32 s65, s65, 7
  s_add_u32 s64, s64, s65
  s_add_u32 s64, s64, 1
  s_mul_i32 s62, s64, 57344
  s_add_u32 s62, s62, s68
  s_add_u32 m0, s96, 131072
  s_nop 0
  buffer_load_dwordx4 v18, s[36:39], s62 offen lds
  buffer_load_dwordx4 v19, s[36:39], s62 offen offset:1024 lds
  buffer_load_dwordx4 v20, s[36:39], s62 offen offset:2048 lds
  buffer_load_dwordx4 v21, s[36:39], s62 offen offset:3072 lds
  s_waitcnt vmcnt(12)
  s_barrier
  s_add_u32 s64, s92, 2
  s_bfe_u32 s65, s64, 0x20001
  s_and_b32 s64, s64, 1
  s_lshl_b32 s64, s64, 2
  s_mul_i32 s65, s65, 7
  s_add_u32 s64, s64, s65
  s_add_u32 s64, s64, 1
  s_lshl_b32 s62, s64, 12
  s_add_u32 s62, s62, 32768
  s_add_u32 s62, s62, s82
  s_add_u32 m0, s96, 32768
  s_nop 0
  buffer_load_dwordx4 v12, s[44:47], s62 offen sc1 lds
  buffer_load_dwordx4 v12, s[44:47], s62 offen offset:1024 sc1 lds
  buffer_load_dwordx4 v12, s[44:47], s62 offen offset:2048 sc1 lds
  buffer_load_dwordx4 v12, s[44:47], s62 offen offset:3072 sc1 lds
  s_add_u32 s64, s92, 0
  s_cmp_ge_u32 s64, 12
  s_cselect_b32 s65, 12, 0
  s_sub_u32 s64, s64, s65
  s_cmp_ge_u32 s64, 12
  s_cselect_b32 s65, 12, 0
  s_sub_u32 s64, s64, s65
  s_mul_i32 s65, s64, 43
  s_lshr_b32 s65, s65, 7
  s_mul_i32 s66, s65, 3
  s_sub_u32 s64, s64, s66
  s_cmp_eq_u32 s64, 2
  s_cselect_b32 s64, 4, s64
  s_mul_i32 s65, s65, 7
  s_add_u32 s64, s64, s65
  s_add_u32 s64, s64, 2
  s_mul_i32 s62, s64, 57344
  s_add_u32 s62, s62, s68
  s_add_u32 m0, s96, 81920
  s_nop 0
  buffer_load_dwordx4 v18, s[36:39], s62 offen lds
  buffer_load_dwordx4 v19, s[36:39], s62 offen offset:1024 lds
  buffer_load_dwordx4 v20, s[36:39], s62 offen offset:2048 lds
  buffer_load_dwordx4 v21, s[36:39], s62 offen offset:3072 lds
  s_waitcnt vmcnt(12)
  s_barrier
  s_add_u32 s64, s92, 4
  s_bfe_u32 s65, s64, 0x20001
  s_and_b32 s64, s64, 1
  s_lshl_b32 s64, s64, 2
  s_mul_i32 s65, s65, 7
  s_add_u32 s64, s64, s65
  s_add_u32 s64, s64, 1
  s_lshl_b32 s62, s64, 12
  s_add_u32 s62, s62, 32768
  s_add_u32 s62, s62, s82
  s_add_u32 m0, s96, 0
  s_nop 0
  buffer_load_dwordx4 v12, s[44:47], s62 offen sc1 lds
  buffer_load_dwordx4 v12, s[44:47], s62 offen offset:1024 sc1 lds
  buffer_load_dwordx4 v12, s[44:47], s62 offen offset:2048 sc1 lds
  buffer_load_dwordx4 v12, s[44:47], s62 offen offset:3072 sc1 lds
  s_add_u32 s64, s92, 2
  s_cmp_ge_u32 s64, 12
  s_cselect_b32 s65, 12, 0
  s_sub_u32 s64, s64, s65
  s_cmp_ge_u32 s64, 12
  s_cselect_b32 s65, 12, 0
  s_sub_u32 s64, s64, s65
  s_mul_i32 s65, s64, 43
  s_lshr_b32 s65, s65, 7
  s_mul_i32 s66, s65, 3
  s_sub_u32 s64, s64, s66
  s_cmp_eq_u32 s64, 2
  s_cselect_b32 s64, 4, s64
  s_mul_i32 s65, s65, 7
  s_add_u32 s64, s64, s65
  s_add_u32 s64, s64, 2
  s_mul_i32 s62, s64, 57344
  s_add_u32 s62, s62, s68
  s_add_u32 m0, s96, 65536
  s_nop 0
  buffer_load_dwordx4 v18, s[36:39], s62 offen lds
  buffer_load_dwordx4 v19, s[36:39], s62 offen offset:1024 lds
  buffer_load_dwordx4 v20, s[36:39], s62 offen offset:2048 lds
  buffer_load_dwordx4 v21, s[36:39], s62 offen offset:3072 lds
  s_waitcnt vmcnt(12)
  s_barrier
  s_add_u32 s64, s92, 6
  s_bfe_u32 s65, s64, 0x20001
  s_and_b32 s64, s64, 1
  s_lshl_b32 s64, s64, 2
  s_mul_i32 s65, s65, 7
  s_add_u32 s64, s64, s65
  s_add_u32 s64, s64, 1
  s_lshl_b32 s62, s64, 12
  s_add_u32 s62, s62, 32768
  s_add_u32 s62, s62, s82
  s_add_u32 m0, s96, 16384
  s_nop 0
  buffer_load_dwordx4 v12, s[44:47], s62 offen sc1 lds
  buffer_load_dwordx4 v12, s[44:47], s62 offen offset:1024 sc1 lds
  buffer_load_dwordx4 v12, s[44:47], s62 offen offset:2048 sc1 lds
  buffer_load_dwordx4 v12, s[44:47], s62 offen offset:3072 sc1 lds
  s_add_u32 s64, s92, 4
  s_cmp_ge_u32 s64, 12
  s_cselect_b32 s65, 12, 0
  s_sub_u32 s64, s64, s65
  s_cmp_ge_u32 s64, 12
  s_cselect_b32 s65, 12, 0
  s_sub_u32 s64, s64, s65
  s_mul_i32 s65, s64, 43
  s_lshr_b32 s65, s65, 7
  s_mul_i32 s66, s65, 3
  s_sub_u32 s64, s64, s66
  s_cmp_eq_u32 s64, 2
  s_cselect_b32 s64, 4, s64
  s_mul_i32 s65, s65, 7
  s_add_u32 s64, s64, s65
  s_add_u32 s64, s64, 2
  s_mul_i32 s62, s64, 57344
  s_add_u32 s62, s62, s68
  s_add_u32 m0, s96, 114688
  s_nop 0
  buffer_load_dwordx4 v18, s[36:39], s62 offen lds
  buffer_load_dwordx4 v19, s[36:39], s62 offen offset:1024 lds
  buffer_load_dwordx4 v20, s[36:39], s62 offen offset:2048 lds
  buffer_load_dwordx4 v21, s[36:39], s62 offen offset:3072 lds
  s_waitcnt vmcnt(12)
  s_barrier
  s_add_u32 s64, s92, 0
  s_cmp_ge_u32 s64, 12
  s_cselect_b32 s65, 12, 0
  s_sub_u32 s64, s64, s65
  s_cmp_ge_u32 s64, 12
  s_cselect_b32 s65, 12, 0
  s_sub_u32 s64, s64, s65
  s_mul_i32 s65, s64, 43
  s_lshr_b32 s65, s65, 7
  s_mul_i32 s66, s65, 3
  s_sub_u32 s64, s64, s66
  s_cmp_eq_u32 s64, 2
  s_cselect_b32 s64, 4, s64
  s_mul_i32 s65, s65, 7
  s_add_u32 s64, s64, s65
  s_add_u32 s64, s64, 2
  s_lshl_b32 s62, s64, 12
  s_add_u32 s62, s62, 32768
  s_add_u32 s62, s62, s82
  s_add_u32 m0, s96, 32768
  s_nop 0
  buffer_load_dwordx4 v12, s[44:47], s62 offen sc1 lds
  buffer_load_dwordx4 v12, s[44:47], s62 offen offset:1024 sc1 lds
  buffer_load_dwordx4 v12, s[44:47], s62 offen offset:2048 sc1 lds
  buffer_load_dwordx4 v12, s[44:47], s62 offen offset:3072 sc1 lds
  s_add_u32 s64, s92, 6
  s_cmp_ge_u32 s64, 12
  s_cselect_b32 s65, 12, 0
  s_sub_u32 s64, s64, s65
  s_cmp_ge_u32 s64, 12
  s_cselect_b32 s65, 12, 0
  s_sub_u32 s64, s64, s65
  s_mul_i32 s65, s64, 43
  s_lshr_b32 s65, s65, 7
  s_mul_i32 s66, s65, 3
  s_sub_u32 s64, s64, s66
  s_cmp_eq_u32 s64, 2
  s_cselect_b32 s64, 4, s64
  s_mul_i32 s65, s65, 7
  s_add_u32 s64, s64, s65
  s_add_u32 s64, s64, 2
  s_mul_i32 s62, s64, 57344
  s_add_u32 s62, s62, s68
  s_add_u32 m0, s96, 98304
  s_nop 0
  buffer_load_dwordx4 v18, s[36:39], s62 offen lds
  buffer_load_dwordx4 v19, s[36:39], s62 offen offset:1024 lds
  buffer_load_dwordx4 v20, s[36:39], s62 offen offset:2048 lds
  buffer_load_dwordx4 v21, s[36:39], s62 offen offset:3072 lds
  s_waitcnt vmcnt(12)
  s_barrier
  s_add_u32 s64, s92, 2
  s_cmp_ge_u32 s64, 12
  s_cselect_b32 s65, 12, 0
  s_sub_u32 s64, s64, s65
  s_cmp_ge_u32 s64, 12
  s_cselect_b32 s65, 12, 0
  s_sub_u32 s64, s64, s65
  s_mul_i32 s65, s64, 43
  s_lshr_b32 s65, s65, 7
  s_mul_i32 s66, s65, 3
  s_sub_u32 s64, s64, s66
  s_cmp_eq_u32 s64, 2
  s_cselect_b32 s64, 4, s64
  s_mul_i32 s65, s65, 7
  s_add_u32 s64, s64, s65
  s_add_u32 s64, s64, 2
  s_lshl_b32 s62, s64, 12
  s_add_u32 s62, s62, 32768
  s_add_u32 s62, s62, s82
  s_add_u32 m0, s96, 0
  s_nop 0
  buffer_load_dwordx4 v12, s[44:47], s62 offen sc1 lds
  buffer_load_dwordx4 v12, s[44:47], s62 offen offset:1024 sc1 lds
  buffer_load_dwordx4 v12, s[44:47], s62 offen offset:2048 sc1 lds
  buffer_load_dwordx4 v12, s[44:47], s62 offen offset:3072 sc1 lds
  s_add_u32 s64, s92, 8
  s_cmp_ge_u32 s64, 12
  s_cselect_b32 s65, 12, 0
  s_sub_u32 s64, s64, s65
  s_cmp_ge_u32 s64, 12
  s_cselect_b32 s65, 12, 0
  s_sub_u32 s64, s64, s65
  s_mul_i32 s65, s64, 43
  s_lshr_b32 s65, s65, 7
  s_mul_i32 s66, s65, 3
  s_sub_u32 s64, s64, s66
  s_cmp_eq_u32 s64, 2
  s_cselect_b32 s64, 4, s64
  s_mul_i32 s65, s65, 7
  s_add_u32 s64, s64, s65
  s_add_u32 s64, s64, 2
  s_mul_i32 s62, s64, 57344
  s_add_u32 s62, s62, s68
  s_add_u32 m0, s96, 147456
  s_nop 0
  buffer_load_dwordx4 v18, s[36:39], s62 offen lds
  buffer_load_dwordx4 v19, s[36:39], s62 offen offset:1024 lds
  buffer_load_dwordx4 v20, s[36:39], s62 offen offset:2048 lds
  buffer_load_dwordx4 v21, s[36:39], s62 offen offset:3072 lds
  s_waitcnt vmcnt(12)
  s_barrier
  s_add_u32 s64, s92, 4
  s_cmp_ge_u32 s64, 12
  s_cselect_b32 s65, 12, 0
  s_sub_u32 s64, s64, s65
  s_cmp_ge_u32 s64, 12
  s_cselect_b32 s65, 12, 0
  s_sub_u32 s64, s64, s65
  s_mul_i32 s65, s64, 43
  s_lshr_b32 s65, s65, 7
  s_mul_i32 s66, s65, 3
  s_sub_u32 s64, s64, s66
  s_cmp_eq_u32 s64, 2
  s_cselect_b32 s64, 4, s64
  s_mul_i32 s65, s65, 7
  s_add_u32 s64, s64, s65
  s_add_u32 s64, s64, 2
  s_lshl_b32 s62, s64, 12
  s_add_u32 s62, s62, 32768
  s_add_u32 s62, s62, s82
  s_add_u32 m0, s96, 16384
  s_nop 0
  buffer_load_dwordx4 v12, s[44:47], s62 offen sc1 lds
  buffer_load_dwordx4 v12, s[44:47], s62 offen offset:1024 sc1 lds
  buffer_load_dwordx4 v12, s[44:47], s62 offen offset:2048 sc1 lds
  buffer_load_dwordx4 v12, s[44:47], s62 offen offset:3072 sc1 lds
  s_add_u32 s64, s92, 10
  s_cmp_ge_u32 s64, 12
  s_cselect_b32 s65, 12, 0
  s_sub_u32 s64, s64, s65
  s_cmp_ge_u32 s64, 12
  s_cselect_b32 s65, 12, 0
  s_sub_u32 s64, s64, s65
  s_mul_i32 s65, s64, 43
  s_lshr_b32 s65, s65, 7
  s_mul_i32 s66, s65, 3
  s_sub_u32 s64, s64, s66
  s_cmp_eq_u32 s64, 2
  s_cselect_b32 s64, 4, s64
  s_mul_i32 s65, s65, 7
  s_add_u32 s64, s64, s65
  s_add_u32 s64, s64, 2
  s_mul_i32 s62, s64, 57344
  s_add_u32 s62, s62, s68
  s_add_u32 m0, s96, 131072
  s_nop 0
  buffer_load_dwordx4 v18, s[36:39], s62 offen lds
  buffer_load_dwordx4 v19, s[36:39], s62 offen offset:1024 lds
  buffer_load_dwordx4 v20, s[36:39], s62 offen offset:2048 lds
  buffer_load_dwordx4 v21, s[36:39], s62 offen offset:3072 lds
  s_waitcnt vmcnt(12)
  s_barrier
  s_add_u32 s64, s92, 6
  s_cmp_ge_u32 s64, 12
  s_cselect_b32 s65, 12, 0
  s_sub_u32 s64, s64, s65
  s_cmp_ge_u32 s64, 12
  s_cselect_b32 s65, 12, 0
  s_sub_u32 s64, s64, s65
  s_mul_i32 s65, s64, 43
  s_lshr_b32 s65, s65, 7
  s_mul_i32 s66, s65, 3
  s_sub_u32 s64, s64, s66
  s_cmp_eq_u32 s64, 2
  s_cselect_b32 s64, 4, s64
  s_mul_i32 s65, s65, 7
  s_add_u32 s64, s64, s65
  s_add_u32 s64, s64, 2
  s_lshl_b32 s62, s64, 12
  s_add_u32 s62, s62, 32768
  s_add_u32 s62, s62, s82
  s_add_u32 m0, s96, 32768
  s_nop 0
  buffer_load_dwordx4 v12, s[44:47], s62 offen sc1 lds
  buffer_load_dwordx4 v12, s[44:47], s62 offen offset:1024 sc1 lds
  buffer_load_dwordx4 v12, s[44:47], s62 offen offset:2048 sc1 lds
  buffer_load_dwordx4 v12, s[44:47], s62 offen offset:3072 sc1 lds
  s_add_u32 s64, s92, 0
  s_and_b32 s64, s64, 7
  s_mul_i32 s62, s64, 50176
  s_add_u32 s62, s62, s69
  s_add_u32 m0, s96, 81920
  s_nop 0
  buffer_load_dwordx4 v18, s[40:43], s62 offen lds
  buffer_load_dwordx4 v19, s[40:43], s62 offen offset:1024 lds
  buffer_load_dwordx4 v20, s[40:43], s62 offen offset:2048 lds
  buffer_load_dwordx4 v21, s[40:43], s62 offen offset:3072 lds
  s_waitcnt vmcnt(12)
  s_barrier
  s_add_u32 s64, s92, 8
  s_cmp_ge_u32 s64, 12
  s_cselect_b32 s65, 12, 0
  s_sub_u32 s64, s64, s65
  s_cmp_ge_u32 s64, 12
  s_cselect_b32 s65, 12, 0
  s_sub_u32 s64, s64, s65
  s_mul_i32 s65, s64, 43
  s_lshr_b32 s65, s65, 7
  s_mul_i32 s66, s65, 3
  s_sub_u32 s64, s64, s66
  s_cmp_eq_u32 s64, 2
  s_cselect_b32 s64, 4, s64
  s_mul_i32 s65, s65, 7
  s_add_u32 s64, s64, s65
  s_add_u32 s64, s64, 2
  s_lshl_b32 s62, s64, 12
  s_add_u32 s62, s62, 32768
  s_add_u32 s62, s62, s82
  s_add_u32 m0, s96, 0
  s_nop 0
  buffer_load_dwordx4 v12, s[44:47], s62 offen sc1 lds
  buffer_load_dwordx4 v12, s[44:47], s62 offen offset:1024 sc1 lds
  buffer_load_dwordx4 v12, s[44:47], s62 offen offset:2048 sc1 lds
  buffer_load_dwordx4 v12, s[44:47], s62 offen offset:3072 sc1 lds
  s_add_u32 s64, s92, 2
  s_and_b32 s64, s64, 7
  s_mul_i32 s62, s64, 50176
  s_add_u32 s62, s62, s69
  s_add_u32 m0, s96, 65536
  s_nop 0
  buffer_load_dwordx4 v18, s[40:43], s62 offen lds
  buffer_load_dwordx4 v19, s[40:43], s62 offen offset:1024 lds
  buffer_load_dwordx4 v20, s[40:43], s62 offen offset:2048 lds
  buffer_load_dwordx4 v21, s[40:43], s62 offen offset:3072 lds
  s_waitcnt vmcnt(12)
  s_barrier
  s_add_u32 s64, s92, 10
  s_cmp_ge_u32 s64, 12
  s_cselect_b32 s65, 12, 0
  s_sub_u32 s64, s64, s65
  s_cmp_ge_u32 s64, 12
  s_cselect_b32 s65, 12, 0
  s_sub_u32 s64, s64, s65
  s_mul_i32 s65, s64, 43
  s_lshr_b32 s65, s65, 7
  s_mul_i32 s66, s65, 3
  s_sub_u32 s64, s64, s66
  s_cmp_eq_u32 s64, 2
  s_cselect_b32 s64, 4, s64
  s_mul_i32 s65, s65, 7
  s_add_u32 s64, s64, s65
  s_add_u32 s64, s64, 2
  s_lshl_b32 s62, s64, 12
  s_add_u32 s62, s62, 32768
  s_add_u32 s62, s62, s82
  s_add_u32 m0, s96, 16384
  s_nop 0
  buffer_load_dwordx4 v12, s[44:47], s62 offen sc1 lds
  buffer_load_dwordx4 v12, s[44:47], s62 offen offset:1024 sc1 lds
  buffer_load_dwordx4 v12, s[44:47], s62 offen offset:2048 sc1 lds
  buffer_load_dwordx4 v12, s[44:47], s62 offen offset:3072 sc1 lds
  s_add_u32 s64, s92, 4
  s_and_b32 s64, s64, 7
  s_mul_i32 s62, s64, 50176
  s_add_u32 s62, s62, s69
  s_add_u32 m0, s96, 114688
  s_nop 0
  buffer_load_dwordx4 v18, s[40:43], s62 offen lds
  buffer_load_dwordx4 v19, s[40:43], s62 offen offset:1024 lds
  buffer_load_dwordx4 v20, s[40:43], s62 offen offset:2048 lds
  buffer_load_dwordx4 v21, s[40:43], s62 offen offset:3072 lds
  s_waitcnt vmcnt(12)
  s_barrier
  s_add_u32 s64, s92, 0
  s_and_b32 s64, s64, 7
  s_lshl_b32 s62, s64, 12
  s_add_u32 s62, s62, s82
  s_add_u32 m0, s96, 32768
  s_nop 0
  buffer_load_dwordx4 v12, s[44:47], s62 offen sc1 lds
  buffer_load_dwordx4 v12, s[44:47], s62 offen offset:1024 sc1 lds
  buffer_load_dwordx4 v12, s[44:47], s62 offen offset:2048 sc1 lds
  buffer_load_dwordx4 v12, s[44:47], s62 offen offset:3072 sc1 lds
  s_add_u32 s64, s92, 6
  s_and_b32 s64, s64, 7
  s_mul_i32 s62, s64, 50176
  s_add_u32 s62, s62, s69
  s_add_u32 m0, s96, 98304
  s_nop 0
  buffer_load_dwordx4 v18, s[40:43], s62 offen lds
  buffer_load_dwordx4 v19, s[40:43], s62 offen offset:1024 lds
  buffer_load_dwordx4 v20, s[40:43], s62 offen offset:2048 lds
  buffer_load_dwordx4 v21, s[40:43], s62 offen offset:3072 lds
  s_waitcnt vmcnt(12)
  s_barrier
  s_add_u32 s64, s92, 2
  s_and_b32 s64, s64, 7
  s_lshl_b32 s62, s64, 12
  s_add_u32 s62, s62, s82
  s_add_u32 m0, s96, 0
  s_nop 0
  buffer_load_dwordx4 v12, s[44:47], s62 offen sc1 lds
  buffer_load_dwordx4 v12, s[44:47], s62 offen offset:1024 sc1 lds
  buffer_load_dwordx4 v12, s[44:47], s62 offen offset:2048 sc1 lds
  buffer_load_dwordx4 v12, s[44:47], s62 offen offset:3072 sc1 lds
  s_waitcnt vmcnt(8)
  s_barrier
  s_add_u32 s64, s92, 4
  s_and_b32 s64, s64, 7
  s_lshl_b32 s62, s64, 12
  s_add_u32 s62, s62, s82
  s_add_u32 m0, s96, 16384
  s_nop 0
  buffer_load_dwordx4 v12, s[44:47], s62 offen sc1 lds
  buffer_load_dwordx4 v12, s[44:47], s62 offen offset:1024 sc1 lds
  buffer_load_dwordx4 v12, s[44:47], s62 offen offset:2048 sc1 lds
  buffer_load_dwordx4 v12, s[44:47], s62 offen offset:3072 sc1 lds
  s_waitcnt vmcnt(4)
  s_barrier
  s_add_u32 s64, s92, 6
  s_and_b32 s64, s64, 7
  s_lshl_b32 s62, s64, 12
  s_add_u32 s62, s62, s82
  s_add_u32 m0, s96, 32768
  s_nop 0
  buffer_load_dwordx4 v12, s[44:47], s62 offen sc1 lds
  buffer_load_dwordx4 v12, s[44:47], s62 offen offset:1024 sc1 lds
  buffer_load_dwordx4 v12, s[44:47], s62 offen offset:2048 sc1 lds
  buffer_load_dwordx4 v12, s[44:47], s62 offen offset:3072 sc1 lds
  s_waitcnt vmcnt(4)
  s_barrier
  s_waitcnt vmcnt(0)
  s_barrier
  s_branch L_fin
L_att:
  s_cmp_eq_u32 s63, 6
  s_cselect_b32 s67, 1, 0
  s_xor_b32 s66, s66, s67
  s_add_u32 s54, s63, s66
  s_mov_b32 s58, s54
  s_mul_i32 s62, s53, 114688
  s_lshl_b32 s63, s55, 7
  s_add_u32 s62, s62, s63
  s_sub_u32 s63, s62, 896
  s_mul_i32 s64, s55, 172032
  s_mul_i32 s65, s54, 112
  s_add_u32 s64, s64, s65
  s_sub_u32 s65, s64, 1204224
  s_cmp_ge_u32 s55, 7
  s_cselect_b32 s68, s63, s62
  s_cselect_b32 s75, s65, s64
  s_cmp_ge_u32 s55, 6
  s_cselect_b32 s69, s63, s62
  s_cselect_b32 s76, s65, s64
  s_add_u32 s69, s69, 128
  s_add_u32 s76, s76, 172032
  s_cmp_ge_u32 s55, 5
  s_cselect_b32 s70, s63, s62
  s_cselect_b32 s77, s65, s64
  s_add_u32 s70, s70, 256
  s_add_u32 s77, s77, 344064
  s_cmp_ge_u32 s55, 4
  s_cselect_b32 s71, s63, s62
  s_cselect_b32 s78, s65, s64
  s_add_u32 s71, s71, 384
  s_add_u32 s78, s78, 516096
  s_cmp_ge_u32 s55, 3
  s_cselect_b32 s72, s63, s62
  s_cselect_b32 s79, s65, s64
  s_add_u32 s72, s72, 512
  s_add_u32 s79, s79, 688128
  s_cmp_ge_u32 s55, 2
  s_cselect_b32 s73, s63, s62
  s_cselect_b32 s80, s65, s64
  s_add_u32 s73, s73, 640
  s_add_u32 s80, s80, 860160
  s_cmp_ge_u32 s55, 1
  s_cselect_b32 s74, s63, s62
  s_cselect_b32 s81, s65, s64
  s_add_u32 s74, s74, 768
  s_add_u32 s81, s81, 1032192
  v_lshl_add_u32 v99, s52, 3, v96
  v_mul_u32_u24 v99, 2688, v99
  v_min_u32 v100, 6, v101
  v_lshl_add_u32 v4, v100, 4, v99
  s_waitcnt lgkmcnt(0)
  s_load_dwordx4 s[20:23], s[0:1], 64
  s_load_dwordx2 s[24:25], s[0:1], 80
  s_lshl_b32 s10, s52, 10
  s_lshl_b32 s11, s52, 11
  s_mov_b32 s28, s4
  s_mov_b32 s29, s5
  s_mov_b32 s30, 1835008
  s_mov_b32 s31, 0x20000
  s_mov_b32 s32, s6
  s_mov_b32 s33, s7
  s_mov_b32 s34, 1204224
  s_mov_b32 s35, 0x20000
  s_add_u32 m0, s11, 65536
  s_nop 0
  buffer_load_dwordx4 v2, s[28:31], s68 offen lds
  s_add_u32 m0, s11, 65536
  s_nop 0
  buffer_load_dwordx4 v3, s[28:31], s68 offen offset:1024 lds
  s_add_u32 m0, s10, 81024
  s_nop 0
  buffer_load_dwordx4 v4, s[32:35], s75 offen offset:896 lds
  s_add_u32 m0, s10, 88320
  s_nop 0
  buffer_load_dwordx4 v4, s[32:35], s75 offen offset:1792 lds
  s_barrier
  s_and_b32 s59, s52, 3
  s_lshr_b32 s93, s52, 2
  v_and_b32 v102, 31, v1
  v_lshrrev_b32 v103, 5, v1
  v_bfe_u32 v104, v1, 1, 3
  v_xor_b32 v104, v104, v103
  v_lshlrev_b32 v104, 4, v104
  v_lshl_add_u32 v104, v102, 7, v104
  s_lshl_b32 s66, s59, 12
  s_add_u32 s66, s66, 65536
  s_mul_i32 s62, s93, 7
  v_xor_b32 v6, 0, v104
  v_add_u32 v6, s66, v6
  v_xor_b32 v7, 32, v104
  v_add_u32 v7, s66, v7
  v_xor_b32 v8, 64, v104
  v_add_u32 v8, s66, v8
  v_xor_b32 v9, 96, v104
  v_add_u32 v9, s66, v9
  v_bfe_u32 v105, v1, 2, 2
  v_and_b32 v106, 3, v1
  v_bfe_u32 v107, v1, 4, 1
  v_lshl_add_u32 v108, v107, 2, v106
  v_lshl_add_u32 v109, v103, 3, v105
  v_add_u32 v110, s62, v108
  v_lshrrev_b32 v97, 1, v110
  v_and_b32 v98, 2, v105
  v_lshlrev_b32 v98, 1, v98
  v_xor_b32 v97, v97, v98
  v_and_b32 v110, 1, v110
  v_lshlrev_b32 v110, 3, v110
  v_lshl_add_u32 v110, v97, 4, v110
  v_lshl_add_u32 v11, v109, 7, v110
  v_add_u32 v10, 81920, v11
  v_lshlrev_b32 v110, 2, v1
  ds_write_b32 v110, v22 offset:57344
  s_add_u32 m0, s11, 131072
  s_nop 0
  buffer_load_dwordx4 v2, s[28:31], s69 offen lds
  s_add_u32 m0, s11, 131072
  s_nop 0
  buffer_load_dwordx4 v3, s[28:31], s69 offen offset:1024 lds
  s_add_u32 m0, s10, 146560
  s_nop 0
  buffer_load_dwordx4 v4, s[32:35], s76 offen offset:896 lds
  s_add_u32 m0, s10, 153856
  s_nop 0
  buffer_load_dwordx4 v4, s[32:35], s76 offen offset:1792 lds
  s_add_u32 s62, s52, s55
  s_cmp_ge_u32 s62, 7
  s_cselect_b32 s63, 7, 0
  s_sub_u32 s62, s62, s63
  s_lshl_b32 s62, s62, 7
  v_lshl_add_u32 v111, v1, 1, s62
  global_load_ushort v14, v111, s[18:19]
  s_waitcnt vmcnt(5) lgkmcnt(0)
  s_barrier
  ds_read_b128 a[0:3], v6
  ds_read_b128 a[4:7], v7
  ds_read_b128 a[8:11], v8
  ds_read_b128 a[12:15], v9
  ds_read_b64_tr_b16 v[64:65], v10 offset:0
  ds_read_b64_tr_b16 v[66:67], v10 offset:512
  ds_read_b64_tr_b16 v[68:69], v10 offset:2048
  ds_read_b64_tr_b16 v[70:71], v10 offset:2560
  ds_read_b64_tr_b16 v[72:73], v10 offset:4096
  ds_read_b64_tr_b16 v[74:75], v10 offset:4608
  ds_read_b64_tr_b16 v[76:77], v10 offset:6144
  ds_read_b64_tr_b16 v[78:79], v10 offset:6656
  s_waitcnt lgkmcnt(6)
  v_mfma_f32_32x32x16_bf16 v[32:47], a[0:3], v[64:67], 0
  ds_read_b64_tr_b16 v[80:81], v10 offset:8192
  ds_read_b64_tr_b16 v[82:83], v10 offset:8704
  s_add_u32 m0, s11, 98304
  s_nop 0
  buffer_load_dwordx4 v2, s[28:31], s70 offen lds
  s_mov_b32 s44, s24
  s_mov_b32 s45, s25
  s_mov_b32 s46, 17825792
  s_mov_b32 s47, 0x20000
  v_lshlrev_b32 v12, 4, v1
  s_lshl_b32 s66, s53, 2
  s_add_u32 s66, s66, s59
  s_mul_i32 s82, s66, 147456
  s_waitcnt lgkmcnt(6)
  v_mfma_f32_32x32x16_bf16 v[32:47], a[4:7], v[68:71], v[32:47]
  ds_read_b64_tr_b16 v[84:85], v10 offset:10240
  ds_read_b64_tr_b16 v[86:87], v10 offset:10752
  s_add_u32 m0, s11, 98304
  s_nop 0
  buffer_load_dwordx4 v3, s[28:31], s70 offen offset:1024 lds
  s_cmp_lg_u32 s52, 1
  s_cbranch_scc1 L_skip_13
  v_mov_b32 v112, 0
  v_mov_b32 v113, 0
  v_mov_b32 v114, 0
  v_mov_b32 v115, 0
  s_lshl_b32 s62, s54, 13
  s_lshl_b32 s63, s53, 9
  s_add_u32 s62, s62, s63
  s_add_u32 s62, s62, 16777216
  s_mov_b32 exec_hi, 0
  buffer_store_dwordx4 v[112:115], v12, s[44:47], s62 offen sc0 sc1
  s_mov_b64 exec, -1
L_skip_13:
  s_waitcnt lgkmcnt(6)
  v_mfma_f32_32x32x16_bf16 v[32:47], a[8:11], v[72:75], v[32:47]
  ds_read_b64_tr_b16 v[88:89], v10 offset:12288
  ds_read_b64_tr_b16 v[90:91], v10 offset:12800
  s_add_u32 m0, s10, 113792
  s_nop 0
  buffer_load_dwordx4 v4, s[32:35], s77 offen offset:896 lds
  v_cmp_eq_u32 vcc, 28, v102
  v_mov_b32 v116, 0x3f803f80
  v_mov_b32 v15, 0
  v_cndmask_b32 v5, 0, v116, vcc
  v_bfe_u32 v117, v1, 1, 1
  v_lshlrev_b32 v117, 6, v117
  v_xor_b32 v117, 0x70, v117
  v_lshl_add_u32 v117, v1, 7, v117
  s_lshl_b32 s62, s52, 13
  v_add_u32 v117, s62, v117
  s_waitcnt lgkmcnt(6)
  v_mfma_f32_32x32x16_bf16 v[32:47], a[12:15], v[76:79], v[32:47]
  ds_read_b64_tr_b16 v[92:93], v10 offset:14336
  ds_read_b64_tr_b16 v[94:95], v10 offset:14848
  s_add_u32 m0, s10, 121088
  s_nop 0
  buffer_load_dwordx4 v4, s[32:35], s77 offen offset:1792 lds
  s_waitcnt lgkmcnt(6)
  v_mfma_f32_32x32x16_bf16 v[48:63], a[0:3], v[80:83], 0
  s_waitcnt vmcnt(5) lgkmcnt(0)
  s_barrier
  v_add_u32 v6, 0x10000, v6
  v_add_u32 v7, 0x10000, v7
  v_add_u32 v8, 0x10000, v8
  v_add_u32 v9, 0x10000, v9
  v_add_u32 v10, 0x10000, v10
  ds_read_b128 a[16:19], v6
  ds_read_b128 a[20:23], v7
  ds_read_b128 a[24:27], v8
  ds_read_b128 a[28:31], v9
  ds_read_b64_tr_b16 v[64:65], v10 offset:0
  ds_read_b64_tr_b16 v[66:67], v10 offset:512
  s_add_u32 m0, s11, 65536
  s_nop 0
  buffer_load_dwordx4 v2, s[28:31], s71 offen lds
  v_mfma_f32_32x32x16_bf16 v[48:63], a[4:7], v[84:87], v[48:63]
  ds_read_b64_tr_b16 v[68:69], v10 offset:2048
  ds_read_b64_tr_b16 v[70:71], v10 offset:2560
  global_load_dwordx2 v[16:17], v22, s[22:23] sc1
  v_mfma_f32_32x32x16_bf16 v[48:63], a[8:11], v[88:91], v[48:63]
  ds_read_b64_tr_b16 v[72:73], v10 offset:4096
  ds_read_b64_tr_b16 v[74:75], v10 offset:4608
  s_add_u32 m0, s11, 65536
  s_nop 0
  buffer_load_dwordx4 v3, s[28:31], s71 offen offset:1024 lds
  v_mfma_f32_32x32x16_bf16 v[48:63], a[12:15], v[92:95], v[48:63]
  ds_read_b64_tr_b16 v[76:77], v10 offset:6144
  ds_read_b64_tr_b16 v[78:79], v10 offset:6656
  s_lshr_b32 s65, s2, 3
  s_mul_i32 s66, s65, 37
  s_lshr_b32 s66, s66, 8
  s_mul_i32 s67, s66, 7
  s_sub_u32 s57, s65, s67
  s_and_b32 s62, s2, 7
  s_lshl_b32 s56, s62, 2
  s_add_u32 s56, s56, s66
  s_add_u32 s85, s57, s66
  s_lshl_b32 s85, s85, 1
  s_and_b32 s85, s2, 7
  s_lshl_b32 s85, s85, 1
  s_waitcnt lgkmcnt(6)
  v_mfma_f32_32x32x16_bf16 v[32:47], a[16:19], v[64:67], v[32:47]
  ds_read_b64_tr_b16 v[80:81], v10 offset:8192
  ds_read_b64_tr_b16 v[82:83], v10 offset:8704
  s_add_u32 m0, s10, 81024
  s_nop 0
  buffer_load_dwordx4 v4, s[32:35], s78 offen offset:896 lds
  s_waitcnt lgkmcnt(6)
  v_mfma_f32_32x32x16_bf16 v[32:47], a[20:23], v[68:71], v[32:47]
  ds_read_b64_tr_b16 v[84:85], v10 offset:10240
  ds_read_b64_tr_b16 v[86:87], v10 offset:10752
  s_lshr_b32 s63, s56, 1
  s_mul_i32 s88, s52, 7168
  s_lshl_b32 s62, s57, 7
  s_add_u32 s88, s88, s62
  s_lshl_b32 s83, s63, 9
  s_add_u32 s83, s83, 16852992
  s_lshl_b32 s89, s54, 8
  s_add_u32 s89, s89, 16850944
  s_waitcnt lgkmcnt(6)
  v_mfma_f32_32x32x16_bf16 v[32:47], a[24:27], v[72:75], v[32:47]
  ds_read_b64_tr_b16 v[88:89], v10 offset:12288
  ds_read_b64_tr_b16 v[90:91], v10 offset:12800
  s_add_u32 m0, s10, 88320
  s_nop 0
  buffer_load_dwordx4 v4, s[32:35], s78 offen offset:1792 lds
  s_waitcnt lgkmcnt(6)
  v_mfma_f32_32x32x16_bf16 v[32:47], a[28:31], v[76:79], v[32:47]
  ds_read_b64_tr_b16 v[92:93], v10 offset:14336
  ds_read_b64_tr_b16 v[94:95], v10 offset:14848
  s_waitcnt lgkmcnt(6)
  v_mfma_f32_32x32x16_bf16 v[48:63], a[16:19], v[80:83], v[48:63]
  s_waitcnt vmcnt(5) lgkmcnt(0)
  s_barrier
  v_add_u32 v6, 0xffff8000, v6
  v_add_u32 v7, 0xffff8000, v7
  v_add_u32 v8, 0xffff8000, v8
  v_add_u32 v9, 0xffff8000, v9
  v_add_u32 v10, 0xffff8000, v10
  ds_read_b128 a[32:35], v6
  ds_read_b128 a[36:39], v7
  ds_read_b128 a[40:43], v8
  ds_read_b128 a[44:47], v9
  ds_read_b64_tr_b16 v[64:65], v10 offset:0
  ds_read_b64_tr_b16 v[66:67], v10 offset:512
  s_add_u32 m0, s11, 131072
  s_nop 0
  buffer_load_dwordx4 v2, s[28:31], s72 offen lds
  v_mfma_f32_32x32x16_bf16 v[48:63], a[20:23], v[84:87], v[48:63]
  ds_read_b64_tr_b16 v[68:69], v10 offset:2048
  ds_read_b64_tr_b16 v[70:71], v10 offset:2560
  s_cmp_eq_u32 s52, 7
  s_cbranch_scc1 L_skip_14
  ds_write_b64 v117, v[14:15] offset:0
L_skip_14:
  v_mfma_f32_32x32x16_bf16 v[48:63], a[24:27], v[88:91], v[48:63]
  ds_read_b64_tr_b16 v[72:73], v10 offset:4096
  ds_read_b64_tr_b16 v[74:75], v10 offset:4608
  s_add_u32 m0, s11, 131072
  s_nop 0
  buffer_load_dwordx4 v3, s[28:31], s72 offen offset:1024 lds
  v_mfma_f32_32x32x16_bf16 v[48:63], a[28:31], v[92:95], v[48:63]
  ds_read_b64_tr_b16 v[76:77], v10 offset:6144
  ds_read_b64_tr_b16 v[78:79], v10 offset:6656
  s_mov_b32 s36, s16
  s_mov_b32 s37, s17
  s_mov_b32 s38, 1605632
  s_mov_b32 s39, 0x20000
  s_mov_b32 s40, s8
  s_mov_b32 s41, s9
  s_mov_b32 s42, 401408
  s_mov_b32 s43, 0x20000
  s_waitcnt lgkmcnt(6)
  v_mfma_f32_32x32x16_bf16 v[32:47], a[32:35], v[64:67], v[32:47]
  ds_read_b64_tr_b16 v[80:81], v10 offset:8192
  ds_read_b64_tr_b16 v[82:83], v10 offset:8704
  s_add_u32 m0, s10, 146560
  s_nop 0
  buffer_load_dwordx4 v4, s[32:35], s79 offen offset:896 lds
  s_waitcnt lgkmcnt(6)
  v_mfma_f32_32x32x16_bf16 v[32:47], a[36:39], v[68:71], v[32:47]
  ds_read_b64_tr_b16 v[84:85], v10 offset:10240
  ds_read_b64_tr_b16 v[86:87], v10 offset:10752
  s_mov_b32 s26, 0x3fb8aa3b
  s_mov_b32 s27, 0x3fb8aa3b
  s_mov_b32 s86, 0x358637bd
  s_mov_b32 s87, 0x358637bd
  v_and_b32 v13, 15, v1
  v_lshlrev_b32 v13, 3, v13
  v_lshlrev_b32 v31, 6, v109
  v_lshl_add_u32 v31, v108, 3, v31
  v_add_u32 v31, 98304, v31
  s_waitcnt lgkmcnt(6)
  v_mfma_f32_32x32x16_bf16 v[32:47], a[40:43], v[72:75], v[32:47]
  ds_read_b64_tr_b16 v[88:89], v10 offset:12288
  ds_read_b64_tr_b16 v[90:91], v10 offset:12800
  s_add_u32 m0, s10, 153856
  s_nop 0
  buffer_load_dwordx4 v4, s[32:35], s79 offen offset:1792 lds
  s_waitcnt lgkmcnt(6)
  v_mfma_f32_32x32x16_bf16 v[32:47], a[44:47], v[76:79], v[32:47]
  ds_read_b64_tr_b16 v[92:93], v10 offset:14336
  ds_read_b64_tr_b16 v[94:95], v10 offset:14848
  s_waitcnt lgkmcnt(6)
  v_mfma_f32_32x32x16_bf16 v[48:63], a[32:35], v[80:83], v[48:63]
  s_waitcnt vmcnt(4) lgkmcnt(0)
  s_barrier
  v_add_u32 v6, 0xffff8000, v6
  v_add_u32 v7, 0xffff8000, v7
  v_add_u32 v8, 0xffff8000, v8
  v_add_u32 v9, 0xffff8000, v9
  v_add_u32 v10, 0xffff8000, v10
  ds_read_b128 a[48:51], v6
  ds_read_b128 a[52:55], v7
  ds_read_b128 a[56:59], v8
  ds_read_b128 a[60:63], v9
  ds_read_b64_tr_b16 v[64:65], v10 offset:0
  ds_read_b64_tr_b16 v[66:67], v10 offset:512
  s_add_u32 m0, s11, 98304
  s_nop 0
  buffer_load_dwordx4 v2, s[28:31], s73 offen lds
  v_mfma_f32_32x32x16_bf16 v[48:63], a[36:39], v[84:87], v[48:63]
  ds_read_b64_tr_b16 v[68:69], v10 offset:2048
  ds_read_b64_tr_b16 v[70:71], v10 offset:2560
  v_lshl_add_u32 v100, v103, 2, v105
  s_and_b32 s62, s52, 1
  s_lshl_b32 s63, s62, 3
  v_add_u32 v110, s63, v108
  v_lshrrev_b32 v97, 1, v110
  v_and_b32 v98, 2, v105
  v_lshlrev_b32 v98, 1, v98
  v_xor_b32 v97, v97, v98
  v_and_b32 v110, 1, v110
  v_lshlrev_b32 v110, 3, v110
  v_lshl_add_u32 v110, v97, 4, v110
  v_lshl_add_u32 v27, v100, 7, v110
  v_add_u32 v28, 114688, v27
  v_add_u32 v27, 65536, v27
  v_mfma_f32_32x32x16_bf16 v[48:63], a[40:43], v[88:91], v[48:63]
  ds_read_b64_tr_b16 v[72:73], v10 offset:4096
  ds_read_b64_tr_b16 v[74:75], v10 offset:4608
  s_add_u32 m0, s11, 98304
  s_nop 0
  buffer_load_dwordx4 v3, s[28:31], s73 offen offset:1024 lds
  v_mfma_f32_32x32x16_bf16 v[48:63], a[44:47], v[92:95], v[48:63]
  ds_read_b64_tr_b16 v[76:77], v10 offset:6144
  ds_read_b64_tr_b16 v[78:79], v10 offset:6656
  s_and_b32 s62, s52, 1
  s_bfe_u32 s63, s52, 0x10001
  s_lshl_b32 s64, s63, 12
  v_add_u32 v26, s64, v12
  s_lshl_b32 s64, s56, 1
  s_add_u32 s64, s64, s63
  s_mul_i32 s90, s64, 28672
  s_lshl_b32 s65, s57, 7
  s_add_u32 s90, s90, s65
  s_lshl_b32 s62, s62, 6
  s_add_u32 s90, s90, s62
  s_lshl_b32 s64, s64, 7
  s_add_u32 s64, s64, 16842752
  v_lshl_add_u32 v30, v102, 2, s64
  s_waitcnt lgkmcnt(6)
  v_mfma_f32_32x32x16_bf16 v[32:47], a[48:51], v[64:67], v[32:47]
  ds_read_b64_tr_b16 v[80:81], v10 offset:8192
  ds_read_b64_tr_b16 v[82:83], v10 offset:8704
  s_add_u32 m0, s10, 113792
  s_nop 0
  buffer_load_dwordx4 v4, s[32:35], s80 offen offset:896 lds
  s_waitcnt lgkmcnt(6)
  v_mfma_f32_32x32x16_bf16 v[32:47], a[52:55], v[68:71], v[32:47]
  ds_read_b64_tr_b16 v[84:85], v10 offset:10240
  ds_read_b64_tr_b16 v[86:87], v10 offset:10752
  s_mov_b32 s48, s20
  s_mov_b32 s49, s21
  s_mov_b32 s50, 1835008
  s_mov_b32 s51, 0x20000
  s_waitcnt lgkmcnt(6)
  v_mfma_f32_32x32x16_bf16 v[32:47], a[56:59], v[72:75], v[32:47]
  ds_read_b64_tr_b16 v[88:89], v10 offset:12288
  ds_read_b64_tr_b16 v[90:91], v10 offset:12800
  s_add_u32 m0, s10, 121088
  s_nop 0
  buffer_load_dwordx4 v4, s[32:35], s80 offen offset:1792 lds
  s_waitcnt lgkmcnt(6)
  v_mfma_f32_32x32x16_bf16 v[32:47], a[60:63], v[76:79], v[32:47]
  ds_read_b64_tr_b16 v[92:93], v10 offset:14336
  ds_read_b64_tr_b16 v[94:95], v10 offset:14848
  s_waitcnt lgkmcnt(6)
  v_mfma_f32_32x32x16_bf16 v[48:63], a[48:51], v[80:83], v[48:63]
  s_waitcnt vmcnt(4) lgkmcnt(0)
  s_barrier
  v_add_u32 v6, 0x10000, v6
  v_add_u32 v7, 0x10000, v7
  v_add_u32 v8, 0x10000, v8
  v_add_u32 v9, 0x10000, v9
  v_add_u32 v10, 0x10000, v10
  ds_read_b128 a[64:67], v6
  ds_read_b128 a[68:71], v7
  ds_read_b128 a[72:75], v8
  ds_read_b128 a[76:79], v9
  ds_read_b64_tr_b16 v[64:65], v10 offset:0
  ds_read_b64_tr_b16 v[66:67], v10 offset:512
  s_add_u32 m0, s11, 65536
  s_nop 0
  buffer_load_dwordx4 v2, s[28:31], s74 offen lds
  v_mfma_f32_32x32x16_bf16 v[48:63], a[52:55], v[84:87], v[48:63]
  ds_read_b64_tr_b16 v[68:69], v10 offset:2048
  ds_read_b64_tr_b16 v[70:71], v10 offset:2560
  v_mul_u32_u24 v29, 896, v102
  v_lshl_add_u32 v29, v103, 4, v29
  v_mul_u32_u24 v99, 896, v96
  v_lshl_add_u32 v18, v101, 4, v99
  v_add_u32 v19, 6144, v18
  v_add_u32 v20, 12288, v18
  v_add_u32 v21, 18432, v18
  v_mfma_f32_32x32x16_bf16 v[48:63], a[56:59], v[88:91], v[48:63]
  ds_read_b64_tr_b16 v[72:73], v10 offset:4096
  ds_read_b64_tr_b16 v[74:75], v10 offset:4608
  s_add_u32 m0, s11, 65536
  s_nop 0
  buffer_load_dwordx4 v3, s[28:31], s74 offen offset:1024 lds
  v_mfma_f32_32x32x16_bf16 v[48:63], a[60:63], v[92:95], v[48:63]
  ds_read_b64_tr_b16 v[76:77], v10 offset:6144
  ds_read_b64_tr_b16 v[78:79], v10 offset:6656
  s_waitcnt lgkmcnt(6)
  v_mfma_f32_32x32x16_bf16 v[32:47], a[64:67], v[64:67], v[32:47]
  ds_read_b64_tr_b16 v[80:81], v10 offset:8192
  ds_read_b64_tr_b16 v[82:83], v10 offset:8704
  s_mov_b32 s84, 65536
  s_branch L_nchk_17
L_non_15:
  s_sleep 1
  global_load_dwordx2 v[16:17], v22, s[22:23] sc1
  s_waitcnt vmcnt(0)
L_nchk_17:
  v_readfirstlane_b32 s60, v16
  v_readfirstlane_b32 s61, v17
  s_nop 3
  s_cmp_lg_u32 s61, 0
  s_cbranch_scc1 L_nok_16
  s_sub_u32 s84, s84, 1
  s_cmp_lg_u32 s84, 0
  s_cbranch_scc1 L_non_15
L_nok_16:
  s_cmp_lg_u32 s52, 1
  s_cbranch_scc1 L_skip_18
  s_lshl_b32 s62, s54, 8
  s_lshl_b32 s63, s53, 3
  s_add_u32 s62, s62, s63
  s_add_u32 s62, s62, 16850944
  v_mov_b32 v24, s60
  v_mov_b32 v25, s61
  s_mov_b64 exec, 1
  buffer_store_dwordx2 v[24:25], v22, s[44:47], s62 offen sc0 sc1
  s_mov_b64 exec, -1
L_skip_18:
  s_waitcnt lgkmcnt(6)
  v_mfma_f32_32x32x16_bf16 v[32:47], a[68:71], v[68:71], v[32:47]
  ds_read_b64_tr_b16 v[84:85], v10 offset:10240
  ds_read_b64_tr_b16 v[86:87], v10 offset:10752
  s_add_u32 m0, s10, 81024
  s_nop 0
  buffer_load_dwordx4 v4, s[32:35], s81 offen offset:896 lds
  s_waitcnt lgkmcnt(6)
  v_mfma_f32_32x32x16_bf16 v[32:47], a[72:75], v[72:75], v[32:47]
  ds_read_b64_tr_b16 v[88:89], v10 offset:12288
  ds_read_b64_tr_b16 v[90:91], v10 offset:12800
  s_add_u32 m0, s10, 88320
  s_nop 0
  buffer_load_dwordx4 v4, s[32:35], s81 offen offset:1792 lds
  s_waitcnt lgkmcnt(6)
  v_mfma_f32_32x32x16_bf16 v[32:47], a[76:79], v[76:79], v[32:47]
  ds_read_b64_tr_b16 v[92:93], v10 offset:14336
  ds_read_b64_tr_b16 v[94:95], v10 offset:14848
  s_waitcnt lgkmcnt(6)
  v_mfma_f32_32x32x16_bf16 v[48:63], a[64:67], v[80:83], v[48:63]
  s_waitcnt vmcnt(4) lgkmcnt(0)
  s_barrier
  v_add_u32 v6, 0xffff8000, v6
  v_add_u32 v7, 0xffff8000, v7
  v_add_u32 v8, 0xffff8000, v8
  v_add_u32 v9, 0xffff8000, v9
  v_add_u32 v10, 0xffff8000, v10
  ds_read_b128 a[80:83], v6
  ds_read_b128 a[84:87], v7
  ds_read_b128 a[88:91], v8
  ds_read_b128 a[92:95], v9
  ds_read_b64_tr_b16 v[64:65], v10 offset:0
  ds_read_b64_tr_b16 v[66:67], v10 offset:512
  s_add_u32 m0, s10, 0
  s_mov_b32 exec_lo, 0xf7f77f7f
  s_mov_b32 exec_hi, 0xf7f77f7f
  buffer_load_dwordx4 v4, s[32:35], s75 offen lds
  s_mov_b64 exec, -1
  v_mfma_f32_32x32x16_bf16 v[48:63], a[68:71], v[84:87], v[48:63]
  ds_read_b64_tr_b16 v[68:69], v10 offset:2048
  ds_read_b64_tr_b16 v[70:71], v10 offset:2560
  v_mfma_f32_32x32x16_bf16 v[48:63], a[72:75], v[88:91], v[48:63]
  ds_read_b64_tr_b16 v[72:73], v10 offset:4096
  ds_read_b64_tr_b16 v[74:75], v10 offset:4608
  s_add_u32 m0, s10, 8192
  s_mov_b32 exec_lo, 0xf7f77f7f
  s_mov_b32 exec_hi, 0xf7f77f7f
  buffer_load_dwordx4 v4, s[32:35], s76 offen lds
  s_mov_b64 exec, -1
  v_mfma_f32_32x32x16_bf16 v[48:63], a[76:79], v[92:95], v[48:63]
  ds_read_b64_tr_b16 v[76:77], v10 offset:6144
  ds_read_b64_tr_b16 v[78:79], v10 offset:6656
  s_waitcnt lgkmcnt(6)
  v_mfma_f32_32x32x16_bf16 v[32:47], a[80:83], v[64:67], v[32:47]
  ds_read_b64_tr_b16 v[80:81], v10 offset:8192
  ds_read_b64_tr_b16 v[82:83], v10 offset:8704
  s_add_u32 m0, s10, 16384
  s_mov_b32 exec_lo, 0xf7f77f7f
  s_mov_b32 exec_hi, 0xf7f77f7f
  buffer_load_dwordx4 v4, s[32:35], s77 offen lds
  s_mov_b64 exec, -1
  s_waitcnt lgkmcnt(6)
  v_mfma_f32_32x32x16_bf16 v[32:47], a[84:87], v[68:71], v[32:47]
  ds_read_b64_tr_b16 v[84:85], v10 offset:10240
  ds_read_b64_tr_b16 v[86:87], v10 offset:10752
  s_waitcnt lgkmcnt(6)
  v_mfma_f32_32x32x16_bf16 v[32:47], a[88:91], v[72:75], v[32:47]
  ds_read_b64_tr_b16 v[88:89], v10 offset:12288
  ds_read_b64_tr_b16 v[90:91], v10 offset:12800
  s_add_u32 m0, s10, 24576
  s_mov_b32 exec_lo, 0xf7f77f7f
  s_mov_b32 exec_hi, 0xf7f77f7f
  buffer_load_dwordx4 v4, s[32:35], s78 offen lds
  s_mov_b64 exec, -1
  s_waitcnt lgkmcnt(6)
  v_mfma_f32_32x32x16_bf16 v[32:47], a[92:95], v[76:79], v[32:47]
  ds_read_b64_tr_b16 v[92:93], v10 offset:14336
  ds_read_b64_tr_b16 v[94:95], v10 offset:14848
  s_waitcnt lgkmcnt(6)
  v_mfma_f32_32x32x16_bf16 v[48:63], a[80:83], v[80:83], v[48:63]
  s_waitcnt vmcnt(4) lgkmcnt(0)
  s_barrier
  v_add_u32 v6, 0xffff8000, v6
  v_add_u32 v7, 0xffff8000, v7
  v_add_u32 v8, 0xffff8000, v8
  v_add_u32 v9, 0xffff8000, v9
  v_add_u32 v10, 0xffff8000, v10
  ds_read_b128 a[96:99], v6
  ds_read_b128 a[100:103], v7
  ds_read_b128 a[104:107], v8
  ds_read_b128 a[108:111], v9
  ds_read_b64_tr_b16 v[64:65], v10 offset:0
  ds_read_b64_tr_b16 v[66:67], v10 offset:512
  buffer_load_dwordx2 v[16:17], v13, s[44:47], s89 offen offset:0 sc1
  v_mfma_f32_32x32x16_bf16 v[48:63], a[84:87], v[84:87], v[48:63]
  ds_read_b64_tr_b16 v[68:69], v10 offset:2048
  ds_read_b64_tr_b16 v[70:71], v10 offset:2560
  v_mfma_f32_32x32x16_bf16 v[48:63], a[88:91], v[88:91], v[48:63]
  ds_read_b64_tr_b16 v[72:73], v10 offset:4096
  ds_read_b64_tr_b16 v[74:75], v10 offset:4608
  v_mfma_f32_32x32x16_bf16 v[48:63], a[92:95], v[92:95], v[48:63]
  ds_read_b64_tr_b16 v[76:77], v10 offset:6144
  ds_read_b64_tr_b16 v[78:79], v10 offset:6656
  s_add_u32 m0, s10, 32768
  s_mov_b32 exec_lo, 0xf7f77f7f
  s_mov_b32 exec_hi, 0xf7f77f7f
  buffer_load_dwordx4 v4, s[32:35], s79 offen lds
  s_mov_b64 exec, -1
  s_waitcnt lgkmcnt(6)
  v_mfma_f32_32x32x16_bf16 v[32:47], a[96:99], v[64:67], v[32:47]
  ds_read_b64_tr_b16 v[80:81], v10 offset:8192
  ds_read_b64_tr_b16 v[82:83], v10 offset:8704
  s_waitcnt lgkmcnt(6)
  v_mfma_f32_32x32x16_bf16 v[32:47], a[100:103], v[68:71], v[32:47]
  ds_read_b64_tr_b16 v[84:85], v10 offset:10240
  ds_read_b64_tr_b16 v[86:87], v10 offset:10752
  s_waitcnt lgkmcnt(6)
  v_mfma_f32_32x32x16_bf16 v[32:47], a[104:107], v[72:75], v[32:47]
  ds_read_b64_tr_b16 v[88:89], v10 offset:12288
  ds_read_b64_tr_b16 v[90:91], v10 offset:12800
  s_add_u32 m0, s10, 40960
  s_mov_b32 exec_lo, 0xf7f77f7f
  s_mov_b32 exec_hi, 0xf7f77f7f
  buffer_load_dwordx4 v4, s[32:35], s80 offen lds
  s_mov_b64 exec, -1
  s_waitcnt lgkmcnt(6)
  v_mfma_f32_32x32x16_bf16 v[32:47], a[108:111], v[76:79], v[32:47]
  ds_read_b64_tr_b16 v[92:93], v10 offset:14336
  ds_read_b64_tr_b16 v[94:95], v10 offset:14848
  s_waitcnt lgkmcnt(6)
  v_mfma_f32_32x32x16_bf16 v[48:63], a[96:99], v[80:83], v[48:63]
  s_waitcnt lgkmcnt(4)
  v_mfma_f32_32x32x16_bf16 v[48:63], a[100:103], v[84:87], v[48:63]
  s_add_u32 m0, s10, 49152
  s_mov_b32 exec_lo, 0xf7f77f7f
  s_mov_b32 exec_hi, 0xf7f77f7f
  buffer_load_dwordx4 v4, s[32:35], s81 offen lds
  s_mov_b64 exec, -1
  s_waitcnt lgkmcnt(2)
  v_mfma_f32_32x32x16_bf16 v[48:63], a[104:107], v[88:91], v[48:63]
  s_waitcnt lgkmcnt(0)
  v_mfma_f32_32x32x16_bf16 v[48:63], a[108:111], v[92:95], v[48:63]
  s_nop 7
  v_pk_mul_f32 v[96:97], s[26:27], v[32:33]
  v_pk_mul_f32 v[98:99], s[26:27], v[34:35]
  v_pk_mul_f32 v[100:101], s[26:27], v[36:37]
  v_pk_mul_f32 v[102:103], s[26:27], v[38:39]
  v_exp_f32_e64 v96, v96 clamp
  v_exp_f32_e64 v97, v97 clamp
  v_exp_f32_e64 v98, v98 clamp
  v_exp_f32_e64 v99, v99 clamp
  v_exp_f32_e64 v100, v100 clamp
  v_exp_f32_e64 v101, v101 clamp
  v_exp_f32_e64 v102, v102 clamp
  v_exp_f32_e64 v103, v103 clamp
  v_max_f32 v104, 0, v32
  v_max_f32 v105, 0, v33
  v_max_f32 v106, 0, v34
  v_max_f32 v107, 0, v35
  v_max_f32 v108, 0, v36
  v_max_f32 v109, 0, v37
  v_max_f32 v110, 0, v38
  v_max_f32 v111, 0, v39
  v_pk_add_f32 v[96:97], v[96:97], v[104:105]
  v_pk_add_f32 v[98:99], v[98:99], v[106:107]
  v_pk_add_f32 v[100:101], v[100:101], v[108:109]
  v_pk_add_f32 v[102:103], v[102:103], v[110:111]
  v_pk_add_f32 v[96:97], s[86:87], v[96:97]
  v_pk_add_f32 v[98:99], s[86:87], v[98:99]
  v_pk_add_f32 v[100:101], s[86:87], v[100:101]
  v_pk_add_f32 v[102:103], s[86:87], v[102:103]
  v_cvt_pk_bf16_f32 v120, v96, v97
  v_cvt_pk_bf16_f32 v121, v98, v99
  v_cvt_pk_bf16_f32 v122, v100, v101
  v_cvt_pk_bf16_f32 v123, v102, v103
  v_pk_mul_f32 v[96:97], s[26:27], v[40:41]
  v_pk_mul_f32 v[98:99], s[26:27], v[42:43]
  v_pk_mul_f32 v[100:101], s[26:27], v[44:45]
  v_pk_mul_f32 v[102:103], s[26:27], v[46:47]
  v_exp_f32_e64 v96, v96 clamp
  v_exp_f32_e64 v97, v97 clamp
  v_exp_f32_e64 v98, v98 clamp
  v_exp_f32_e64 v99, v99 clamp
  v_exp_f32_e64 v100, v100 clamp
  v_exp_f32_e64 v101, v101 clamp
  v_exp_f32_e64 v102, v102 clamp
  v_exp_f32_e64 v103, v103 clamp
  v_max_f32 v104, 0, v40
  v_max_f32 v105, 0, v41
  v_max_f32 v106, 0, v42
  v_max_f32 v107, 0, v43
  v_max_f32 v108, 0, v44
  v_max_f32 v109, 0, v45
  v_max_f32 v110, 0, v46
  v_max_f32 v111, 0, v47
  v_pk_add_f32 v[96:97], v[96:97], v[104:105]
  v_pk_add_f32 v[98:99], v[98:99], v[106:107]
  v_pk_add_f32 v[100:101], v[100:101], v[108:109]
  v_pk_add_f32 v[102:103], v[102:103], v[110:111]
  v_pk_add_f32 v[96:97], s[86:87], v[96:97]
  v_pk_add_f32 v[98:99], s[86:87], v[98:99]
  v_pk_add_f32 v[100:101], s[86:87], v[100:101]
  v_pk_add_f32 v[102:103], s[86:87], v[102:103]
  v_cvt_pk_bf16_f32 v124, v96, v97
  v_cvt_pk_bf16_f32 v125, v98, v99
  v_cvt_pk_bf16_f32 v126, v100, v101
  v_cvt_pk_bf16_f32 v127, v102, v103
  v_cvt_pk_bf16_f32 v64, v48, v49
  v_cvt_pk_bf16_f32 v65, v50, v51
  v_cvt_pk_bf16_f32 v66, v52, v53
  v_cvt_pk_bf16_f32 v67, v54, v55
  v_cvt_pk_bf16_f32 v68, v56, v57
  v_cvt_pk_bf16_f32 v69, v58, v59
  v_cvt_pk_bf16_f32 v70, v60, v61
  v_cvt_pk_bf16_f32 v71, v62, v63
  s_mov_b32 exec_lo, 0xf0000000
  s_mov_b32 exec_hi, 0xf0000000
  v_mov_b32 v120, 0
  v_mov_b32 v64, v5
  v_mov_b32 v121, 0
  v_mov_b32 v65, v5
  v_mov_b32 v122, 0
  v_mov_b32 v66, v5
  v_mov_b32 v123, 0
  v_mov_b32 v67, v5
  v_mov_b32 v124, 0
  v_mov_b32 v68, v5
  v_mov_b32 v125, 0
  v_mov_b32 v69, v5
  v_mov_b32 v126, 0
  v_mov_b32 v70, v5
  v_mov_b32 v127, 0
  v_mov_b32 v71, v5
  s_mov_b64 exec, -1
  s_nop 1
  v_mfma_f32_32x32x16_bf16 v[32:47], v[120:123], v[64:67], 0
  v_mfma_f32_32x32x16_bf16 v[32:47], v[124:127], v[68:71], v[32:47]
  s_lshl_b32 s62, s52, 12
  s_add_u32 s62, s62, 98304
  v_add_u32 v96, s62, v12
  s_nop 7
  s_nop 1
  ds_write_b128 v96, v[32:35] offset:0
  ds_write_b128 v96, v[36:39] offset:1024
  ds_write_b128 v96, v[40:43] offset:2048
  ds_write_b128 v96, v[44:47] offset:3072
  s_waitcnt vmcnt(5) lgkmcnt(0)
  s_barrier
  s_lshl_b32 s62, s93, 14
  s_lshl_b32 s63, s59, 10
  s_add_u32 s62, s62, s63
  s_add_u32 s62, s62, 98304
  v_add_u32 v112, s62, v12
  ds_read_b128 v[96:99], v112 offset:0
  ds_read_b128 v[100:103], v112 offset:4096
  ds_read_b128 v[104:107], v112 offset:8192
  ds_read_b128 v[108:111], v112 offset:12288
  s_waitcnt vmcnt(3)
  s_mov_b32 s84, 65536
  s_branch L_pchk_21
L_poll_19:
  s_sleep 1
  buffer_load_dwordx2 v[16:17], v13, s[44:47], s89 offen offset:0 sc1
  s_waitcnt vmcnt(0)
L_pchk_21:
  v_cmp_eq_u64 vcc, s[60:61], v[16:17]
  s_and_b32 s64, vcc_lo, 65535
  s_cmp_eq_u32 s64, 65535
  s_cbranch_scc1 L_pok_20
  s_sub_u32 s84, s84, 1
  s_cmp_lg_u32 s84, 0
  s_cbranch_scc1 L_poll_19
L_pok_20:
  s_waitcnt lgkmcnt(0)
  v_add_f32 v96, v96, v100
  v_add_f32 v104, v104, v108
  v_add_f32 v97, v97, v101
  v_add_f32 v105, v105, v109
  v_add_f32 v98, v98, v102
  v_add_f32 v106, v106, v110
  v_add_f32 v99, v99, v103
  v_add_f32 v107, v107, v111
  v_add_f32 v96, v96, v104
  v_add_f32 v97, v97, v105
  v_add_f32 v98, v98, v106
  v_add_f32 v99, v99, v107
  s_lshl_b32 s62, s54, 13
  s_add_u32 s62, s62, s10
  s_add_u32 s62, s62, 16777216
  v_lshlrev_b32 v113, 2, v1
  buffer_atomic_add_f32 v96, v113, s[44:47], s62 offen offset:0
  buffer_atomic_add_f32 v97, v113, s[44:47], s62 offen offset:256
  buffer_atomic_add_f32 v98, v113, s[44:47], s62 offen offset:512
  buffer_atomic_add_f32 v99, v113, s[44:47], s62 offen offset:768
  ds_read_b64_tr_b16 v[64:65], v11 offset:0
  ds_read_b64_tr_b16 v[66:67], v11 offset:512
  ds_read_b64_tr_b16 v[68:69], v11 offset:2048
  ds_read_b64_tr_b16 v[70:71], v11 offset:2560
  ds_read_b64_tr_b16 v[72:73], v11 offset:4096
  ds_read_b64_tr_b16 v[74:75], v11 offset:4608
  ds_read_b64_tr_b16 v[76:77], v11 offset:6144
  ds_read_b64_tr_b16 v[78:79], v11 offset:6656
  s_waitcnt lgkmcnt(6)
  v_mfma_f32_32x32x16_bf16 v[48:63], v[64:67], a[0:3], 0
  ds_read_b64_tr_b16 v[80:81], v11 offset:8192
  ds_read_b64_tr_b16 v[82:83], v11 offset:8704
  s_add_u32 s64, s85, 0
  s_bfe_u32 s65, s64, 0x20001
  s_and_b32 s64, s64, 1
  s_lshl_b32 s64, s64, 2
  s_mul_i32 s65, s65, 7
  s_add_u32 s64, s64, s65
  s_mul_i32 s62, s64, 57344
  s_add_u32 s62, s62, s88
  s_add_u32 m0, s10, 147456
  s_nop 0
  buffer_load_dwordx4 v18, s[36:39], s62 offen lds
  s_waitcnt lgkmcnt(6)
  v_mfma_f32_32x32x16_bf16 v[48:63], v[68:71], a[4:7], v[48:63]
  ds_read_b64_tr_b16 v[84:85], v11 offset:10240
  ds_read_b64_tr_b16 v[86:87], v11 offset:10752
  s_waitcnt lgkmcnt(6)
  v_mfma_f32_32x32x16_bf16 v[48:63], v[72:75], a[8:11], v[48:63]
  ds_read_b64_tr_b16 v[88:89], v11 offset:12288
  ds_read_b64_tr_b16 v[90:91], v11 offset:12800
  s_add_u32 s64, s85, 1
  s_bfe_u32 s65, s64, 0x20001
  s_and_b32 s64, s64, 1
  s_lshl_b32 s64, s64, 2
  s_mul_i32 s65, s65, 7
  s_add_u32 s64, s64, s65
  s_mul_i32 s62, s64, 57344
  s_add_u32 s62, s62, s88
  s_add_u32 m0, s10, 155648
  s_nop 0
  buffer_load_dwordx4 v18, s[36:39], s62 offen lds
  s_waitcnt lgkmcnt(6)
  v_mfma_f32_32x32x16_bf16 v[48:63], v[76:79], a[12:15], v[48:63]
  ds_read_b64_tr_b16 v[92:93], v11 offset:14336
  ds_read_b64_tr_b16 v[94:95], v11 offset:14848
  s_waitcnt lgkmcnt(6)
  v_mfma_f32_32x32x16_bf16 v[48:63], v[80:83], a[16:19], v[48:63]
  ds_read_b64_tr_b16 v[64:65], v11 offset:16384
  ds_read_b64_tr_b16 v[66:67], v11 offset:16896
  s_add_u32 s64, s85, 2
  s_bfe_u32 s65, s64, 0x20001
  s_and_b32 s64, s64, 1
  s_lshl_b32 s64, s64, 2
  s_mul_i32 s65, s65, 7
  s_add_u32 s64, s64, s65
  s_mul_i32 s62, s64, 57344
  s_add_u32 s62, s62, s88
  s_add_u32 m0, s10, 131072
  s_nop 0
  buffer_load_dwordx4 v18, s[36:39], s62 offen lds
  s_waitcnt lgkmcnt(6)
  v_mfma_f32_32x32x16_bf16 v[48:63], v[84:87], a[20:23], v[48:63]
  ds_read_b64_tr_b16 v[68:69], v11 offset:18432
  ds_read_b64_tr_b16 v[70:71], v11 offset:18944
  s_waitcnt lgkmcnt(6)
  v_mfma_f32_32x32x16_bf16 v[48:63], v[88:91], a[24:27], v[48:63]
  ds_read_b64_tr_b16 v[72:73], v11 offset:20480
  ds_read_b64_tr_b16 v[74:75], v11 offset:20992
  s_waitcnt lgkmcnt(6)
  v_mfma_f32_32x32x16_bf16 v[48:63], v[92:95], a[28:31], v[48:63]
  ds_read_b64_tr_b16 v[76:77], v11 offset:22528
  ds_read_b64_tr_b16 v[78:79], v11 offset:23040
  s_add_u32 s64, s85, 3
  s_bfe_u32 s65, s64, 0x20001
  s_and_b32 s64, s64, 1
  s_lshl_b32 s64, s64, 2
  s_mul_i32 s65, s65, 7
  s_add_u32 s64, s64, s65
  s_mul_i32 s62, s64, 57344
  s_add_u32 s62, s62, s88
  s_add_u32 m0, s10, 139264
  s_nop 0
  buffer_load_dwordx4 v18, s[36:39], s62 offen lds
  s_waitcnt lgkmcnt(6)
  v_mfma_f32_32x32x16_bf16 v[48:63], v[64:67], a[32:35], v[48:63]
  s_waitcnt vmcnt(8)
  s_barrier
  ds_read_b64_tr_b16 v[80:81], v11 offset:24576
  ds_read_b64_tr_b16 v[82:83], v11 offset:25088
  s_waitcnt lgkmcnt(6)
  v_mfma_f32_32x32x16_bf16 v[48:63], v[68:71], a[36:39], v[48:63]
  ds_read_b64_tr_b16 v[84:85], v11 offset:26624
  ds_read_b64_tr_b16 v[86:87], v11 offset:27136
  s_add_u32 s64, s85, 4
  s_bfe_u32 s65, s64, 0x20001
  s_and_b32 s64, s64, 1
  s_lshl_b32 s64, s64, 2
  s_mul_i32 s65, s65, 7
  s_add_u32 s64, s64, s65
  s_mul_i32 s62, s64, 57344
  s_add_u32 s62, s62, s88
  s_add_u32 m0, s10, 81920
  s_nop 0
  buffer_load_dwordx4 v18, s[36:39], s62 offen lds
  s_waitcnt lgkmcnt(6)
  v_mfma_f32_32x32x16_bf16 v[48:63], v[72:75], a[40:43], v[48:63]
  ds_read_b64_tr_b16 v[88:89], v11 offset:28672
  ds_read_b64_tr_b16 v[90:91], v11 offset:29184
  s_waitcnt lgkmcnt(6)
  v_mfma_f32_32x32x16_bf16 v[48:63], v[76:79], a[44:47], v[48:63]
  ds_read_b64_tr_b16 v[92:93], v11 offset:30720
  ds_read_b64_tr_b16 v[94:95], v11 offset:31232
  s_add_u32 s64, s85, 5
  s_bfe_u32 s65, s64, 0x20001
  s_and_b32 s64, s64, 1
  s_lshl_b32 s64, s64, 2
  s_mul_i32 s65, s65, 7
  s_add_u32 s64, s64, s65
  s_mul_i32 s62, s64, 57344
  s_add_u32 s62, s62, s88
  s_add_u32 m0, s10, 90112
  s_nop 0
  buffer_load_dwordx4 v18, s[36:39], s62 offen lds
  s_waitcnt lgkmcnt(6)
  v_mfma_f32_32x32x16_bf16 v[48:63], v[80:83], a[48:51], v[48:63]
  ds_read_b64_tr_b16 v[64:65], v11 offset:32768
  ds_read_b64_tr_b16 v[66:67], v11 offset:33280
  s_waitcnt lgkmcnt(6)
  v_mfma_f32_32x32x16_bf16 v[48:63], v[84:87], a[52:55], v[48:63]
  ds_read_b64_tr_b16 v[68:69], v11 offset:34816
  ds_read_b64_tr_b16 v[70:71], v11 offset:35328
  s_waitcnt lgkmcnt(6)
  v_mfma_f32_32x32x16_bf16 v[48:63], v[88:91], a[56:59], v[48:63]
  ds_read_b64_tr_b16 v[72:73], v11 offset:36864
  ds_read_b64_tr_b16 v[74:75], v11 offset:37376
  s_add_u32 s64, s85, 6
  s_bfe_u32 s65, s64, 0x20001
  s_and_b32 s64, s64, 1
  s_lshl_b32 s64, s64, 2
  s_mul_i32 s65, s65, 7
  s_add_u32 s64, s64, s65
  s_mul_i32 s62, s64, 57344
  s_add_u32 s62, s62, s88
  s_add_u32 m0, s10, 65536
  s_nop 0
  buffer_load_dwordx4 v18, s[36:39], s62 offen lds
  s_waitcnt lgkmcnt(6)
  v_mfma_f32_32x32x16_bf16 v[48:63], v[92:95], a[60:63], v[48:63]
  ds_read_b64_tr_b16 v[76:77], v11 offset:38912
  ds_read_b64_tr_b16 v[78:79], v11 offset:39424
  s_waitcnt lgkmcnt(6)
  v_mfma_f32_32x32x16_bf16 v[48:63], v[64:67], a[64:67], v[48:63]
  ds_read_b64_tr_b16 v[80:81], v11 offset:40960
  ds_read_b64_tr_b16 v[82:83], v11 offset:41472
  s_add_u32 s64, s85, 7
  s_bfe_u32 s65, s64, 0x20001
  s_and_b32 s64, s64, 1
  s_lshl_b32 s64, s64, 2
  s_mul_i32 s65, s65, 7
  s_add_u32 s64, s64, s65
  s_mul_i32 s62, s64, 57344
  s_add_u32 s62, s62, s88
  s_add_u32 m0, s10, 73728
  s_nop 0
  buffer_load_dwordx4 v18, s[36:39], s62 offen lds
  s_waitcnt lgkmcnt(6)
  v_mfma_f32_32x32x16_bf16 v[48:63], v[68:71], a[68:71], v[48:63]
  ds_read_b64_tr_b16 v[84:85], v11 offset:43008
  ds_read_b64_tr_b16 v[86:87], v11 offset:43520
  s_waitcnt lgkmcnt(6)
  v_mfma_f32_32x32x16_bf16 v[48:63], v[72:75], a[72:75], v[48:63]
  ds_read_b64_tr_b16 v[88:89], v11 offset:45056
  ds_read_b64_tr_b16 v[90:91], v11 offset:45568
  s_add_u32 s64, s85, 0
  s_bfe_u32 s65, s64, 0x20001
  s_and_b32 s64, s64, 1
  s_lshl_b32 s64, s64, 2
  s_mul_i32 s65, s65, 7
  s_add_u32 s64, s64, s65
  s_add_u32 s64, s64, 1
  s_mul_i32 s62, s64, 57344
  s_add_u32 s62, s62, s88
  s_add_u32 m0, s10, 114688
  s_nop 0
  buffer_load_dwordx4 v18, s[36:39], s62 offen lds
  s_waitcnt lgkmcnt(6)
  v_mfma_f32_32x32x16_bf16 v[48:63], v[76:79], a[76:79], v[48:63]
  ds_read_b64_tr_b16 v[92:93], v11 offset:47104
  ds_read_b64_tr_b16 v[94:95], v11 offset:47616
  s_waitcnt lgkmcnt(6)
  v_mfma_f32_32x32x16_bf16 v[48:63], v[80:83], a[80:83], v[48:63]
  ds_read_b64_tr_b16 v[64:65], v11 offset:49152
  ds_read_b64_tr_b16 v[66:67], v11 offset:49664
  s_waitcnt lgkmcnt(6)
  v_mfma_f32_32x32x16_bf16 v[48:63], v[84:87], a[84:87], v[48:63]
  ds_read_b64_tr_b16 v[68:69], v11 offset:51200
  ds_read_b64_tr_b16 v[70:71], v11 offset:51712
  s_add_u32 s64, s85, 1
  s_bfe_u32 s65, s64, 0x20001
  s_and_b32 s64, s64, 1
  s_lshl_b32 s64, s64, 2
  s_mul_i32 s65, s65, 7
  s_add_u32 s64, s64, s65
  s_add_u32 s64, s64, 1
  s_mul_i32 s62, s64, 57344
  s_add_u32 s62, s62, s88
  s_add_u32 m0, s10, 122880
  s_nop 0
  buffer_load_dwordx4 v18, s[36:39], s62 offen lds
  s_waitcnt lgkmcnt(6)
  v_mfma_f32_32x32x16_bf16 v[48:63], v[88:91], a[88:91], v[48:63]
  ds_read_b64_tr_b16 v[72:73], v11 offset:53248
  ds_read_b64_tr_b16 v[74:75], v11 offset:53760
  buffer_load_dwordx2 v[16:17], v13, s[44:47], s83 offen offset:0 sc1
  s_waitcnt lgkmcnt(6)
  v_mfma_f32_32x32x16_bf16 v[48:63], v[92:95], a[92:95], v[48:63]
  ds_read_b64_tr_b16 v[76:77], v11 offset:55296
  ds_read_b64_tr_b16 v[78:79], v11 offset:55808
  s_add_u32 s64, s85, 2
  s_bfe_u32 s65, s64, 0x20001
  s_and_b32 s64, s64, 1
  s_lshl_b32 s64, s64, 2
  s_mul_i32 s65, s65, 7
  s_add_u32 s64, s64, s65
  s_add_u32 s64, s64, 1
  s_mul_i32 s62, s64, 57344
  s_add_u32 s62, s62, s88
  s_add_u32 m0, s10, 98304
  s_nop 0
  buffer_load_dwordx4 v18, s[36:39], s62 offen lds
  s_waitcnt lgkmcnt(6)
  v_mfma_f32_32x32x16_bf16 v[48:63], v[64:67], a[96:99], v[48:63]
  s_waitcnt lgkmcnt(4)
  v_mfma_f32_32x32x16_bf16 v[48:63], v[68:71], a[100:103], v[48:63]
  s_add_u32 s64, s85, 3
  s_bfe_u32 s65, s64, 0x20001
  s_and_b32 s64, s64, 1
  s_lshl_b32 s64, s64, 2
  s_mul_i32 s65, s65, 7
  s_add_u32 s64, s64, s65
  s_add_u32 s64, s64, 1
  s_mul_i32 s62, s64, 57344
  s_add_u32 s62, s62, s88
  s_add_u32 m0, s10, 106496
  s_nop 0
  buffer_load_dwordx4 v18, s[36:39], s62 offen lds
  s_waitcnt lgkmcnt(2)
  v_mfma_f32_32x32x16_bf16 v[48:63], v[72:75], a[104:107], v[48:63]
  s_waitcnt lgkmcnt(0)
  v_mfma_f32_32x32x16_bf16 v[48:63], v[76:79], a[108:111], v[48:63]
  s_waitcnt vmcnt(13)
  v_mov_b32 v24, 1
  s_mov_b64 exec, 1
  ds_add_rtn_u32 v25, v22, v24 offset:57344
  s_mov_b64 exec, -1
  s_cmp_lg_u32 s93, 0
  s_cbranch_scc1 L_attB
  s_waitcnt lgkmcnt(0)
  v_readfirstlane_b32 s62, v25
  s_nop 3
  s_cmp_lg_u32 s62, 7
  s_cbranch_scc1 L_skip_22
  s_lshl_b32 s62, s54, 8
  s_lshl_b32 s63, s53, 3
  s_add_u32 s62, s62, s63
  s_add_u32 s62, s62, 16851072
  v_mov_b32 v24, s60
  v_mov_b32 v25, s61
  s_mov_b64 exec, 1
  buffer_store_dwordx2 v[24:25], v22, s[44:47], s62 offen sc0 sc1
  s_mov_b64 exec, -1
L_skip_22:
  s_nop 3
  v_pk_mul_f32 v[96:97], s[26:27], v[48:49]
  v_pk_mul_f32 v[98:99], s[26:27], v[50:51]
  v_pk_mul_f32 v[100:101], s[26:27], v[52:53]
  v_pk_mul_f32 v[102:103], s[26:27], v[54:55]
  v_exp_f32_e64 v96, v96 clamp
  v_exp_f32_e64 v97, v97 clamp
  v_exp_f32_e64 v98, v98 clamp
  v_exp_f32_e64 v99, v99 clamp
  v_exp_f32_e64 v100, v100 clamp
  v_exp_f32_e64 v101, v101 clamp
  v_exp_f32_e64 v102, v102 clamp
  v_exp_f32_e64 v103, v103 clamp
  v_max_f32 v104, 0, v48
  v_max_f32 v105, 0, v49
  v_max_f32 v106, 0, v50
  v_max_f32 v107, 0, v51
  v_max_f32 v108, 0, v52
  v_max_f32 v109, 0, v53
  v_max_f32 v110, 0, v54
  v_max_f32 v111, 0, v55
  v_pk_add_f32 v[96:97], v[96:97], v[104:105]
  v_pk_add_f32 v[98:99], v[98:99], v[106:107]
  v_pk_add_f32 v[100:101], v[100:101], v[108:109]
  v_pk_add_f32 v[102:103], v[102:103], v[110:111]
  v_pk_add_f32 v[96:97], s[86:87], v[96:97]
  v_pk_add_f32 v[98:99], s[86:87], v[98:99]
  v_pk_add_f32 v[100:101], s[86:87], v[100:101]
  v_pk_add_f32 v[102:103], s[86:87], v[102:103]
  v_cvt_pk_bf16_f32 v120, v96, v97
  v_cvt_pk_bf16_f32 v121, v98, v99
  v_cvt_pk_bf16_f32 v122, v100, v101
  v_cvt_pk_bf16_f32 v123, v102, v103
  v_pk_mul_f32 v[96:97], s[26:27], v[56:57]
  v_pk_mul_f32 v[98:99], s[26:27], v[58:59]
  v_pk_mul_f32 v[100:101], s[26:27], v[60:61]
  v_pk_mul_f32 v[102:103], s[26:27], v[62:63]
  v_exp_f32_e64 v96, v96 clamp
  v_exp_f32_e64 v97, v97 clamp
  v_exp_f32_e64 v98, v98 clamp
  v_exp_f32_e64 v99, v99 clamp
  v_exp_f32_e64 v100, v100 clamp
  v_exp_f32_e64 v101, v101 clamp
  v_exp_f32_e64 v102, v102 clamp
  v_exp_f32_e64 v103, v103 clamp
  v_max_f32 v104, 0, v56
  v_max_f32 v105, 0, v57
  v_max_f32 v106, 0, v58
  v_max_f32 v107, 0, v59
  v_max_f32 v108, 0, v60
  v_max_f32 v109, 0, v61
  v_max_f32 v110, 0, v62
  v_max_f32 v111, 0, v63
  v_pk_add_f32 v[96:97], v[96:97], v[104:105]
  v_pk_add_f32 v[98:99], v[98:99], v[106:107]
  v_pk_add_f32 v[100:101], v[100:101], v[108:109]
  v_pk_add_f32 v[102:103], v[102:103], v[110:111]
  v_pk_add_f32 v[96:97], s[86:87], v[96:97]
  v_pk_add_f32 v[98:99], s[86:87], v[98:99]
  v_pk_add_f32 v[100:101], s[86:87], v[100:101]
  v_pk_add_f32 v[102:103], s[86:87], v[102:103]
  v_cvt_pk_bf16_f32 v124, v96, v97
  v_cvt_pk_bf16_f32 v125, v98, v99
  v_cvt_pk_bf16_f32 v126, v100, v101
  v_cvt_pk_bf16_f32 v127, v102, v103
  s_mov_b32 exec_lo, 0
  v_mov_b32 v126, 0
  v_mov_b32 v127, 0
  s_mov_b64 exec, -1
  s_barrier
  s_cmp_ge_u32 s2, 224
  s_cbranch_scc1 L_idleA
  s_waitcnt vmcnt(0)
  s_branch L_cons
L_attB:
  s_waitcnt lgkmcnt(0)
  v_readfirstlane_b32 s62, v25
  s_nop 3
  s_cmp_lg_u32 s62, 7
  s_cbranch_scc1 L_skip_23
  s_lshl_b32 s62, s54, 8
  s_lshl_b32 s63, s53, 3
  s_add_u32 s62, s62, s63
  s_add_u32 s62, s62, 16851072
  v_mov_b32 v24, s60
  v_mov_b32 v25, s61
  s_mov_b64 exec, 1
  buffer_store_dwordx2 v[24:25], v22, s[44:47], s62 offen sc0 sc1
  s_mov_b64 exec, -1
L_skip_23:
  s_sub_u32 s65, s52, 4
  s_lshr_b32 s63, s65, 1
  s_add_u32 s92, s85, s63
  s_and_b32 s62, s65, 1
  s_lshl_b32 s96, s65, 12
  s_lshl_b32 s63, s57, 7
  s_mul_i32 s64, s62, 28672
  s_add_u32 s68, s63, s64
  s_mul_i32 s64, s62, 25088
  s_add_u32 s69, s63, s64
  s_lshl_b32 s63, s56, 1
  s_add_u32 s62, s62, s63
  s_mul_i32 s82, s62, 147456
  s_barrier
  s_cmp_ge_u32 s2, 224
  s_cbranch_scc1 L_skip_24
  s_waitcnt vmcnt(0)
  s_mov_b32 s84, 65536
  s_branch L_pchk_27
L_poll_25:
  s_sleep 1
  buffer_load_dwordx2 v[16:17], v13, s[44:47], s83 offen offset:0 sc1
  s_waitcnt vmcnt(0)
L_pchk_27:
  v_cmp_eq_u64 vcc, s[60:61], v[16:17]
  s_and_b32 s64, vcc_lo, 65280
  s_cmp_eq_u32 s64, 65280
  s_cbranch_scc1 L_pok_26
  s_sub_u32 s84, s84, 1
  s_cmp_lg_u32 s84, 0
  s_cbranch_scc1 L_poll_25
L_pok_26:
  s_add_u32 s64, s92, 0
  s_bfe_u32 s65, s64, 0x20001
  s_and_b32 s64, s64, 1
  s_lshl_b32 s64, s64, 2
  s_mul_i32 s65, s65, 7
  s_add_u32 s64, s64, s65
  s_lshl_b32 s62, s64, 12
  s_add_u32 s62, s62, 32768
  s_add_u32 s62, s62, s82
  s_add_u32 m0, s96, 0
  s_nop 0
  buffer_load_dwordx4 v12, s[44:47], s62 offen sc1 lds
  buffer_load_dwordx4 v12, s[44:47], s62 offen offset:1024 sc1 lds
  buffer_load_dwordx4 v12, s[44:47], s62 offen offset:2048 sc1 lds
  buffer_load_dwordx4 v12, s[44:47], s62 offen offset:3072 sc1 lds
  s_add_u32 s64, s92, 2
  s_bfe_u32 s65, s64, 0x20001
  s_and_b32 s64, s64, 1
  s_lshl_b32 s64, s64, 2
  s_mul_i32 s65, s65, 7
  s_add_u32 s64, s64, s65
  s_lshl_b32 s62, s64, 12
  s_add_u32 s62, s62, 32768
  s_add_u32 s62, s62, s82
  s_add_u32 m0, s96, 16384
  s_nop 0
  buffer_load_dwordx4 v12, s[44:47], s62 offen sc1 lds
  buffer_load_dwordx4 v12, s[44:47], s62 offen offset:1024 sc1 lds
  buffer_load_dwordx4 v12, s[44:47], s62 offen offset:2048 sc1 lds
  buffer_load_dwordx4 v12, s[44:47], s62 offen offset:3072 sc1 lds
  s_add_u32 s64, s92, 4
  s_bfe_u32 s65, s64, 0x20001
  s_and_b32 s64, s64, 1
  s_lshl_b32 s64, s64, 2
  s_mul_i32 s65, s65, 7
  s_add_u32 s64, s64, s65
  s_lshl_b32 s62, s64, 12
  s_add_u32 s62, s62, 32768
  s_add_u32 s62, s62, s82
  s_add_u32 m0, s96, 32768
  s_nop 0
  buffer_load_dwordx4 v12, s[44:47], s62 offen sc1 lds
  buffer_load_dwordx4 v12, s[44:47], s62 offen offset:1024 sc1 lds
  buffer_load_dwordx4 v12, s[44:47], s62 offen offset:2048 sc1 lds
  buffer_load_dwordx4 v12, s[44:47], s62 offen offset:3072 sc1 lds
L_skip_24:
  s_cmp_lg_u32 s54, 0
  s_cbranch_scc1 L_skip_28
  v_mul_f32 v96, s26, v60
  v_exp_f32_e64 v96, -v96
  s_nop 0
  v_add_f32 v96, 1.0, v96
  v_rcp_f32 v96, v96
  v_lshlrev_b32 v97, 2, v1
  s_lshl_b32 s62, s53, 2
  s_add_u32 s62, s62, s59
  s_lshl_b32 s62, s62, 7
  s_add_u32 s62, s62, 16842624
  s_mov_b32 exec_lo, 0
  buffer_store_dword v96, v97, s[44:47], s62 offen sc0 sc1
  s_mov_b64 exec, -1
  s_nop 0
L_skip_28:
  v_pk_mul_f32 v[96:97], s[26:27], v[48:49]
  v_pk_mul_f32 v[98:99], s[26:27], v[50:51]
  v_pk_mul_f32 v[100:101], s[26:27], v[52:53]
  v_pk_mul_f32 v[102:103], s[26:27], v[54:55]
  v_exp_f32_e64 v96, v96 clamp
  v_exp_f32_e64 v97, v97 clamp
  v_exp_f32_e64 v98, v98 clamp
  v_exp_f32_e64 v99, v99 clamp
  v_exp_f32_e64 v100, v100 clamp
  v_exp_f32_e64 v101, v101 clamp
  v_exp_f32_e64 v102, v102 clamp
  v_exp_f32_e64 v103, v103 clamp
  v_max_f32 v104, 0, v48
  v_max_f32 v105, 0, v49
  v_max_f32 v106, 0, v50
  v_max_f32 v107, 0, v51
  v_max_f32 v108, 0, v52
  v_max_f32 v109, 0, v53
  v_max_f32 v110, 0, v54
  v_max_f32 v111, 0, v55
  v_pk_add_f32 v[96:97], v[96:97], v[104:105]
  v_pk_add_f32 v[98:99], v[98:99], v[106:107]
  v_pk_add_f32 v[100:101], v[100:101], v[108:109]
  v_pk_add_f32 v[102:103], v[102:103], v[110:111]
  v_pk_add_f32 v[96:97], s[86:87], v[96:97]
  v_pk_add_f32 v[98:99], s[86:87], v[98:99]
  v_pk_add_f32 v[100:101], s[86:87], v[100:101]
  v_pk_add_f32 v[102:103], s[86:87], v[102:103]
  v_cvt_pk_bf16_f32 v120, v96, v97
  v_cvt_pk_bf16_f32 v121, v98, v99
  v_cvt_pk_bf16_f32 v122, v100, v101
  v_cvt_pk_bf16_f32 v123, v102, v103
  v_pk_mul_f32 v[96:97], s[26:27], v[56:57]
  v_pk_mul_f32 v[98:99], s[26:27], v[58:59]
  v_pk_mul_f32 v[100:101], s[26:27], v[60:61]
  v_pk_mul_f32 v[102:103], s[26:27], v[62:63]
  v_exp_f32_e64 v96, v96 clamp
  v_exp_f32_e64 v97, v97 clamp
  v_exp_f32_e64 v98, v98 clamp
  v_exp_f32_e64 v99, v99 clamp
  v_exp_f32_e64 v100, v100 clamp
  v_exp_f32_e64 v101, v101 clamp
  v_exp_f32_e64 v102, v102 clamp
  v_exp_f32_e64 v103, v103 clamp
  v_max_f32 v104, 0, v56
  v_max_f32 v105, 0, v57
  v_max_f32 v106, 0, v58
  v_max_f32 v107, 0, v59
  v_max_f32 v108, 0, v60
  v_max_f32 v109, 0, v61
  v_max_f32 v110, 0, v62
  v_max_f32 v111, 0, v63
  v_pk_add_f32 v[96:97], v[96:97], v[104:105]
  v_pk_add_f32 v[98:99], v[98:99], v[106:107]
  v_pk_add_f32 v[100:101], v[100:101], v[108:109]
  v_pk_add_f32 v[102:103], v[102:103], v[110:111]
  v_pk_add_f32 v[96:97], s[86:87], v[96:97]
  v_pk_add_f32 v[98:99], s[86:87], v[98:99]
  v_pk_add_f32 v[100:101], s[86:87], v[100:101]
  v_pk_add_f32 v[102:103], s[86:87], v[102:103]
  v_cvt_pk_bf16_f32 v124, v96, v97
  v_cvt_pk_bf16_f32 v125, v98, v99
  v_cvt_pk_bf16_f32 v126, v100, v101
  v_cvt_pk_bf16_f32 v127, v102, v103
  s_mov_b32 exec_lo, 0
  v_mov_b32 v126, 0
  v_mov_b32 v127, 0
  s_mov_b64 exec, -1
  s_cmp_ge_u32 s2, 224
  s_cbranch_scc1 L_idleB
  s_waitcnt vmcnt(8)
  s_barrier
  s_waitcnt vmcnt(4)
  s_barrier
  s_add_u32 s64, s92, 6
  s_bfe_u32 s65, s64, 0x20001
  s_and_b32 s64, s64, 1
  s_lshl_b32 s64, s64, 2
  s_mul_i32 s65, s65, 7
  s_add_u32 s64, s64, s65
  s_lshl_b32 s62, s64, 12
  s_add_u32 s62, s62, 32768
  s_add_u32 s62, s62, s82
  s_add_u32 m0, s96, 0
  s_nop 0
  buffer_load_dwordx4 v12, s[44:47], s62 offen sc1 lds
  buffer_load_dwordx4 v12, s[44:47], s62 offen offset:1024 sc1 lds
  buffer_load_dwordx4 v12, s[44:47], s62 offen offset:2048 sc1 lds
  buffer_load_dwordx4 v12, s[44:47], s62 offen offset:3072 sc1 lds
  s_add_u32 s64, s92, 4
  s_bfe_u32 s65, s64, 0x20001
  s_and_b32 s64, s64, 1
  s_lshl_b32 s64, s64, 2
  s_mul_i32 s65, s65, 7
  s_add_u32 s64, s64, s65
  s_add_u32 s64, s64, 1
  s_mul_i32 s62, s64, 57344
  s_add_u32 s62, s62, s68
  s_add_u32 m0, s96, 147456
  s_nop 0
  buffer_load_dwordx4 v18, s[36:39], s62 offen lds
  buffer_load_dwordx4 v19, s[36:39], s62 offen offset:1024 lds
  buffer_load_dwordx4 v20, s[36:39], s62 offen offset:2048 lds
  buffer_load_dwordx4 v21, s[36:39], s62 offen offset:3072 lds
  s_waitcnt vmcnt(8)
  s_barrier
  s_add_u32 s64, s92, 0
  s_bfe_u32 s65, s64, 0x20001
  s_and_b32 s64, s64, 1
  s_lshl_b32 s64, s64, 2
  s_mul_i32 s65, s65, 7
  s_add_u32 s64, s64, s65
  s_add_u32 s64, s64, 1
  s_lshl_b32 s62, s64, 12
  s_add_u32 s62, s62, 32768
  s_add_u32 s62, s62, s82
  s_add_u32 m0, s96, 16384
  s_nop 0
  buffer_load_dwordx4 v12, s[44:47], s62 offen sc1 lds
  buffer_load_dwordx4 v12, s[44:47], s62 offen offset:1024 sc1 lds
  buffer_load_dwordx4 v12, s[44:47], s62 offen offset:2048 sc1 lds
  buffer_load_dwordx4 v12, s[44:47], s62 offen offset:3072 sc1 lds
  s_add_u32 s64, s92, 6
  s_bfe_u32 s65, s64, 0x20001
  s_and_b32 s64, s64, 1
  s_lshl_b32 s64, s64, 2
  s_mul_i32 s65, s65, 7
  s_add_u32 s64, s64, s65
  s_add_u32 s64, s64, 1
  s_mul_i32 s62, s64, 57344
  s_add_u32 s62, s62, s68
  s_add_u32 m0, s96, 131072
  s_nop 0
  buffer_load_dwordx4 v18, s[36:39], s62 offen lds
  buffer_load_dwordx4 v19, s[36:39], s62 offen offset:1024 lds
  buffer_load_dwordx4 v20, s[36:39], s62 offen offset:2048 lds
  buffer_load_dwordx4 v21, s[36:39], s62 offen offset:3072 lds
  s_waitcnt vmcnt(12)
  s_barrier
  s_lshl_b32 s62, s54, 13
  s_lshl_b32 s63, s59, 11
  s_add_u32 s62, s62, s63
  s_add_u32 s62, s62, 16777216
  s_add_u32 m0, s63, 57344
  s_nop 0
  buffer_load_dwordx4 v12, s[44:47], s62 offen sc1 lds
  buffer_load_dwordx4 v12, s[44:47], s62 offen offset:1024 sc1 lds
  s_add_u32 s64, s92, 2
  s_bfe_u32 s65, s64, 0x20001
  s_and_b32 s64, s64, 1
  s_lshl_b32 s64, s64, 2
  s_mul_i32 s65, s65, 7
  s_add_u32 s64, s64, s65
  s_add_u32 s64, s64, 1
  s_lshl_b32 s62, s64, 12
  s_add_u32 s62, s62, 32768
  s_add_u32 s62, s62, s82
  s_add_u32 m0, s96, 32768
  s_nop 0
  buffer_load_dwordx4 v12, s[44:47], s62 offen sc1 lds
  buffer_load_dwordx4 v12, s[44:47], s62 offen offset:1024 sc1 lds
  buffer_load_dwordx4 v12, s[44:47], s62 offen offset:2048 sc1 lds
  buffer_load_dwordx4 v12, s[44:47], s62 offen offset:3072 sc1 lds
  s_add_u32 s64, s92, 0
  s_cmp_ge_u32 s64, 12
  s_cselect_b32 s65, 12, 0
  s_sub_u32 s64, s64, s65
  s_cmp_ge_u32 s64, 12
  s_cselect_b32 s65, 12, 0
  s_sub_u32 s64, s64, s65
  s_mul_i32 s65, s64, 43
  s_lshr_b32 s65, s65, 7
  s_mul_i32 s66, s65, 3
  s_sub_u32 s64, s64, s66
  s_cmp_eq_u32 s64, 2
  s_cselect_b32 s64, 4, s64
  s_mul_i32 s65, s65, 7
  s_add_u32 s64, s64, s65
  s_add_u32 s64, s64, 2
  s_mul_i32 s62, s64, 57344
  s_add_u32 s62, s62, s68
  s_add_u32 m0, s96, 81920
  s_nop 0
  buffer_load_dwordx4 v18, s[36:39], s62 offen lds
  buffer_load_dwordx4 v19, s[36:39], s62 offen offset:1024 lds
  buffer_load_dwordx4 v20, s[36:39], s62 offen offset:2048 lds
  buffer_load_dwordx4 v21, s[36:39], s62 offen offset:3072 lds
  s_waitcnt vmcnt(14)
  s_barrier
  s_add_u32 s64, s92, 4
  s_bfe_u32 s65, s64, 0x20001
  s_and_b32 s64, s64, 1
  s_lshl_b32 s64, s64, 2
  s_mul_i32 s65, s65, 7
  s_add_u32 s64, s64, s65
  s_add_u32 s64, s64, 1
  s_lshl_b32 s62, s64, 12
  s_add_u32 s62, s62, 32768
  s_add_u32 s62, s62, s82
  s_add_u32 m0, s96, 0
  s_nop 0
  buffer_load_dwordx4 v12, s[44:47], s62 offen sc1 lds
  buffer_load_dwordx4 v12, s[44:47], s62 offen offset:1024 sc1 lds
  buffer_load_dwordx4 v12, s[44:47], s62 offen offset:2048 sc1 lds
  buffer_load_dwordx4 v12, s[44:47], s62 offen offset:3072 sc1 lds
  s_add_u32 s64, s92, 2
  s_cmp_ge_u32 s64, 12
  s_cselect_b32 s65, 12, 0
  s_sub_u32 s64, s64, s65
  s_cmp_ge_u32 s64, 12
  s_cselect_b32 s65, 12, 0
  s_sub_u32 s64, s64, s65
  s_mul_i32 s65, s64, 43
  s_lshr_b32 s65, s65, 7
  s_mul_i32 s66, s65, 3
  s_sub_u32 s64, s64, s66
  s_cmp_eq_u32 s64, 2
  s_cselect_b32 s64, 4, s64
  s_mul_i32 s65, s65, 7
  s_add_u32 s64, s64, s65
  s_add_u32 s64, s64, 2
  s_mul_i32 s62, s64, 57344
  s_add_u32 s62, s62, s68
  s_add_u32 m0, s96, 65536
  s_nop 0
  buffer_load_dwordx4 v18, s[36:39], s62 offen lds
  buffer_load_dwordx4 v19, s[36:39], s62 offen offset:1024 lds
  buffer_load_dwordx4 v20, s[36:39], s62 offen offset:2048 lds
  buffer_load_dwordx4 v21, s[36:39], s62 offen offset:3072 lds
  s_waitcnt vmcnt(12)
  s_barrier
  s_lshl_b32 s62, s93, 12
  s_add_u32 s62, s62, 57344
  v_lshl_add_u32 v112, v1, 2, s62
  ds_read2st64_b32 v[96:97], v112 offset0:0 offset1:1
  ds_read2st64_b32 v[98:99], v112 offset0:2 offset1:3
  ds_read2st64_b32 v[100:101], v112 offset0:4 offset1:5
  s_waitcnt lgkmcnt(3)
  ds_read2st64_b32 v[102:103], v112 offset0:6 offset1:7
  ds_read2st64_b32 v[104:105], v112 offset0:8 offset1:9
  ds_read2st64_b32 v[106:107], v112 offset0:10 offset1:11
  ds_read2st64_b32 v[108:109], v112 offset0:12 offset1:13
  ds_read2st64_b32 v[110:111], v112 offset0:14 offset1:15
  s_waitcnt lgkmcnt(0)
  v_cvt_pk_bf16_f32 v112, v96, v97
  v_cvt_pk_bf16_f32 v113, v98, v99
  v_cvt_pk_bf16_f32 v114, v100, v101
  v_cvt_pk_bf16_f32 v115, v102, v103
  v_cvt_pk_bf16_f32 v116, v104, v105
  v_cvt_pk_bf16_f32 v117, v106, v107
  v_cvt_pk_bf16_f32 v118, v108, v109
  v_cvt_pk_bf16_f32 v119, v110, v111
  s_nop 1
  v_mfma_f32_32x32x16_bf16 v[96:111], v[112:115], v[120:123], 0
  v_mfma_f32_32x32x16_bf16 v[96:111], v[116:119], v[124:127], v[96:111]
  s_lshl_b32 s63, s53, 2
  s_add_u32 s63, s63, s59
  s_mul_i32 s63, s63, 147456
  s_lshl_b32 s62, s54, 1
  s_add_u32 s62, s62, s93
  s_lshl_b32 s62, s62, 11
  s_add_u32 s62, s62, s63
  s_nop 5
  v_mov_b32 v112, v108
  v_mov_b32 v113, v108
  s_nop 1
  v_permlane32_swap_b32 v112, v113
  s_nop 1
  v_add_f32 v113, s86, v113
  v_rcp_f32 v113, v113
  s_nop 0
  v_mul_f32 v96, v96, v113
  v_mul_f32 v97, v97, v113
  v_mul_f32 v98, v98, v113
  v_mul_f32 v99, v99, v113
  v_mul_f32 v100, v100, v113
  v_mul_f32 v101, v101, v113
  v_mul_f32 v102, v102, v113
  v_mul_f32 v103, v103, v113
  v_mul_f32 v104, v104, v113
  v_mul_f32 v105, v105, v113
  v_mul_f32 v106, v106, v113
  v_mul_f32 v107, v107, v113
  v_mul_f32 v108, v108, v113
  v_mul_f32 v109, v109, v113
  v_mul_f32 v110, v110, v113
  v_mul_f32 v111, v111, v113
  v_cvt_pk_bf16_f32 v120, v96, v97
  v_cvt_pk_bf16_f32 v121, v98, v99
  v_cvt_pk_bf16_f32 v122, v100, v101
  v_cvt_pk_bf16_f32 v123, v102, v103
  v_cvt_pk_bf16_f32 v124, v104, v105
  v_cvt_pk_bf16_f32 v125, v106, v107
  v_cvt_pk_bf16_f32 v126, v108, v109
  v_cvt_pk_bf16_f32 v127, v110, v111
  s_mov_b32 exec_lo, 0
  v_mov_b32 v126, 0
  v_mov_b32 v127, 0
  s_mov_b64 exec, -1
  buffer_store_dwordx4 v[120:123], v12, s[44:47], s62 offen sc0 sc1
  buffer_store_dwordx4 v[124:127], v12, s[44:47], s62 offen offset:1024 sc0 sc1
  s_add_u32 s64, s92, 6
  s_bfe_u32 s65, s64, 0x20001
  s_and_b32 s64, s64, 1
  s_lshl_b32 s64, s64, 2
  s_mul_i32 s65, s65, 7
  s_add_u32 s64, s64, s65
  s_add_u32 s64, s64, 1
  s_lshl_b32 s62, s64, 12
  s_add_u32 s62, s62, 32768
  s_add_u32 s62, s62, s82
  s_add_u32 m0, s96, 16384
  s_nop 0
  buffer_load_dwordx4 v12, s[44:47], s62 offen sc1 lds
  buffer_load_dwordx4 v12, s[44:47], s62 offen offset:1024 sc1 lds
  buffer_load_dwordx4 v12, s[44:47], s62 offen offset:2048 sc1 lds
  buffer_load_dwordx4 v12, s[44:47], s62 offen offset:3072 sc1 lds
  s_add_u32 s64, s92, 4
  s_cmp_ge_u32 s64, 12
  s_cselect_b32 s65, 12, 0
  s_sub_u32 s64, s64, s65
  s_cmp_ge_u32 s64, 12
  s_cselect_b32 s65, 12, 0
  s_sub_u32 s64, s64, s65
  s_mul_i32 s65, s64, 43
  s_lshr_b32 s65, s65, 7
  s_mul_i32 s66, s65, 3
  s_sub_u32 s64, s64, s66
  s_cmp_eq_u32 s64, 2
  s_cselect_b32 s64, 4, s64
  s_mul_i32 s65, s65, 7
  s_add_u32 s64, s64, s65
  s_add_u32 s64, s64, 2
  s_mul_i32 s62, s64, 57344
  s_add_u32 s62, s62, s68
  s_add_u32 m0, s96, 114688
  s_nop 0
  buffer_load_dwordx4 v18, s[36:39], s62 offen lds
  buffer_load_dwordx4 v19, s[36:39], s62 offen offset:1024 lds
  buffer_load_dwordx4 v20, s[36:39], s62 offen offset:2048 lds
  buffer_load_dwordx4 v21, s[36:39], s62 offen offset:3072 lds
  s_waitcnt vmcnt(14)
  s_barrier
  s_add_u32 s64, s92, 0
  s_cmp_ge_u32 s64, 12
  s_cselect_b32 s65, 12, 0
  s_sub_u32 s64, s64, s65
  s_cmp_ge_u32 s64, 12
  s_cselect_b32 s65, 12, 0
  s_sub_u32 s64, s64, s65
  s_mul_i32 s65, s64, 43
  s_lshr_b32 s65, s65, 7
  s_mul_i32 s66, s65, 3
  s_sub_u32 s64, s64, s66
  s_cmp_eq_u32 s64, 2
  s_cselect_b32 s64, 4, s64
  s_mul_i32 s65, s65, 7
  s_add_u32 s64, s64, s65
  s_add_u32 s64, s64, 2
  s_lshl_b32 s62, s64, 12
  s_add_u32 s62, s62, 32768
  s_add_u32 s62, s62, s82
  s_add_u32 m0, s96, 32768
  s_nop 0
  buffer_load_dwordx4 v12, s[44:47], s62 offen sc1 lds
  buffer_load_dwordx4 v12, s[44:47], s62 offen offset:1024 sc1 lds
  buffer_load_dwordx4 v12, s[44:47], s62 offen offset:2048 sc1 lds
  buffer_load_dwordx4 v12, s[44:47], s62 offen offset:3072 sc1 lds
  s_add_u32 s64, s92, 6
  s_cmp_ge_u32 s64, 12
  s_cselect_b32 s65, 12, 0
  s_sub_u32 s64, s64, s65
  s_cmp_ge_u32 s64, 12
  s_cselect_b32 s65, 12, 0
  s_sub_u32 s64, s64, s65
  s_mul_i32 s65, s64, 43
  s_lshr_b32 s65, s65, 7
  s_mul_i32 s66, s65, 3
  s_sub_u32 s64, s64, s66
  s_cmp_eq_u32 s64, 2
  s_cselect_b32 s64, 4, s64
  s_mul_i32 s65, s65, 7
  s_add_u32 s64, s64, s65
  s_add_u32 s64, s64, 2
  s_mul_i32 s62, s64, 57344
  s_add_u32 s62, s62, s68
  s_add_u32 m0, s96, 98304
  s_nop 0
  buffer_load_dwordx4 v18, s[36:39], s62 offen lds
  buffer_load_dwordx4 v19, s[36:39], s62 offen offset:1024 lds
  buffer_load_dwordx4 v20, s[36:39], s62 offen offset:2048 lds
  buffer_load_dwordx4 v21, s[36:39], s62 offen offset:3072 lds
  s_waitcnt vmcnt(12)
  s_barrier
  s_add_u32 s64, s92, 2
  s_cmp_ge_u32 s64, 12
  s_cselect_b32 s65, 12, 0
  s_sub_u32 s64, s64, s65
  s_cmp_ge_u32 s64, 12
  s_cselect_b32 s65, 12, 0
  s_sub_u32 s64, s64, s65
  s_mul_i32 s65, s64, 43
  s_lshr_b32 s65, s65, 7
  s_mul_i32 s66, s65, 3
  s_sub_u32 s64, s64, s66
  s_cmp_eq_u32 s64, 2
  s_cselect_b32 s64, 4, s64
  s_mul_i32 s65, s65, 7
  s_add_u32 s64, s64, s65
  s_add_u32 s64, s64, 2
  s_lshl_b32 s62, s64, 12
  s_add_u32 s62, s62, 32768
  s_add_u32 s62, s62, s82
  s_add_u32 m0, s96, 0
  s_nop 0
  buffer_load_dwordx4 v12, s[44:47], s62 offen sc1 lds
  buffer_load_dwordx4 v12, s[44:47], s62 offen offset:1024 sc1 lds
  buffer_load_dwordx4 v12, s[44:47], s62 offen offset:2048 sc1 lds
  buffer_load_dwordx4 v12, s[44:47], s62 offen offset:3072 sc1 lds
  s_add_u32 s64, s92, 8
  s_cmp_ge_u32 s64, 12
  s_cselect_b32 s65, 12, 0
  s_sub_u32 s64, s64, s65
  s_cmp_ge_u32 s64, 12
  s_cselect_b32 s65, 12, 0
  s_sub_u32 s64, s64, s65
  s_mul_i32 s65, s64, 43
  s_lshr_b32 s65, s65, 7
  s_mul_i32 s66, s65, 3
  s_sub_u32 s64, s64, s66
  s_cmp_eq_u32 s64, 2
  s_cselect_b32 s64, 4, s64
  s_mul_i32 s65, s65, 7
  s_add_u32 s64, s64, s65
  s_add_u32 s64, s64, 2
  s_mul_i32 s62, s64, 57344
  s_add_u32 s62, s62, s68
  s_add_u32 m0, s96, 147456
  s_nop 0
  buffer_load_dwordx4 v18, s[36:39], s62 offen lds
  buffer_load_dwordx4 v19, s[36:39], s62 offen offset:1024 lds
  buffer_load_dwordx4 v20, s[36:39], s62 offen offset:2048 lds
  buffer_load_dwordx4 v21, s[36:39], s62 offen offset:3072 lds
  s_waitcnt vmcnt(12)
  s_barrier
  s_add_u32 s64, s92, 4
  s_cmp_ge_u32 s64, 12
  s_cselect_b32 s65, 12, 0
  s_sub_u32 s64, s64, s65
  s_cmp_ge_u32 s64, 12
  s_cselect_b32 s65, 12, 0
  s_sub_u32 s64, s64, s65
  s_mul_i32 s65, s64, 43
  s_lshr_b32 s65, s65, 7
  s_mul_i32 s66, s65, 3
  s_sub_u32 s64, s64, s66
  s_cmp_eq_u32 s64, 2
  s_cselect_b32 s64, 4, s64
  s_mul_i32 s65, s65, 7
  s_add_u32 s64, s64, s65
  s_add_u32 s64, s64, 2
  s_lshl_b32 s62, s64, 12
  s_add_u32 s62, s62, 32768
  s_add_u32 s62, s62, s82
  s_add_u32 m0, s96, 16384
  s_nop 0
  buffer_load_dwordx4 v12, s[44:47], s62 offen sc1 lds
  buffer_load_dwordx4 v12, s[44:47], s62 offen offset:1024 sc1 lds
  buffer_load_dwordx4 v12, s[44:47], s62 offen offset:2048 sc1 lds
  buffer_load_dwordx4 v12, s[44:47], s62 offen offset:3072 sc1 lds
  s_add_u32 s64, s92, 10
  s_cmp_ge_u32 s64, 12
  s_cselect_b32 s65, 12, 0
  s_sub_u32 s64, s64, s65
  s_cmp_ge_u32 s64, 12
  s_cselect_b32 s65, 12, 0
  s_sub_u32 s64, s64, s65
  s_mul_i32 s65, s64, 43
  s_lshr_b32 s65, s65, 7
  s_mul_i32 s66, s65, 3
  s_sub_u32 s64, s64, s66
  s_cmp_eq_u32 s64, 2
  s_cselect_b32 s64, 4, s64
  s_mul_i32 s65, s65, 7
  s_add_u32 s64, s64, s65
  s_add_u32 s64, s64, 2
  s_mul_i32 s62, s64, 57344
  s_add_u32 s62, s62, s68
  s_add_u32 m0, s96, 131072
  s_nop 0
  buffer_load_dwordx4 v18, s[36:39], s62 offen lds
  buffer_load_dwordx4 v19, s[36:39], s62 offen offset:1024 lds
  buffer_load_dwordx4 v20, s[36:39], s62 offen offset:2048 lds
  buffer_load_dwordx4 v21, s[36:39], s62 offen offset:3072 lds
  s_waitcnt vmcnt(12)
  s_barrier
  s_add_u32 s64, s92, 6
  s_cmp_ge_u32 s64, 12
  s_cselect_b32 s65, 12, 0
  s_sub_u32 s64, s64, s65
  s_cmp_ge_u32 s64, 12
  s_cselect_b32 s65, 12, 0
  s_sub_u32 s64, s64, s65
  s_mul_i32 s65, s64, 43
  s_lshr_b32 s65, s65, 7
  s_mul_i32 s66, s65, 3
  s_sub_u32 s64, s64, s66
  s_cmp_eq_u32 s64, 2
  s_cselect_b32 s64, 4, s64
  s_mul_i32 s65, s65, 7
  s_add_u32 s64, s64, s65
  s_add_u32 s64, s64, 2
  s_lshl_b32 s62, s64, 12
  s_add_u32 s62, s62, 32768
  s_add_u32 s62, s62, s82
  s_add_u32 m0, s96, 32768
  s_nop 0
  buffer_load_dwordx4 v12, s[44:47], s62 offen sc1 lds
  buffer_load_dwordx4 v12, s[44:47], s62 offen offset:1024 sc1 lds
  buffer_load_dwordx4 v12, s[44:47], s62 offen offset:2048 sc1 lds
  buffer_load_dwordx4 v12, s[44:47], s62 offen offset:3072 sc1 lds
  s_add_u32 s64, s92, 0
  s_and_b32 s64, s64, 7
  s_mul_i32 s62, s64, 50176
  s_add_u32 s62, s62, s69
  s_add_u32 m0, s96, 81920
  s_nop 0
  buffer_load_dwordx4 v18, s[40:43], s62 offen lds
  buffer_load_dwordx4 v19, s[40:43], s62 offen offset:1024 lds
  buffer_load_dwordx4 v20, s[40:43], s62 offen offset:2048 lds
  buffer_load_dwordx4 v21, s[40:43], s62 offen offset:3072 lds
  s_waitcnt vmcnt(12)
  s_barrier
  s_add_u32 s64, s92, 8
  s_cmp_ge_u32 s64, 12
  s_cselect_b32 s65, 12, 0
  s_sub_u32 s64, s64, s65
  s_cmp_ge_u32 s64, 12
  s_cselect_b32 s65, 12, 0
  s_sub_u32 s64, s64, s65
  s_mul_i32 s65, s64, 43
  s_lshr_b32 s65, s65, 7
  s_mul_i32 s66, s65, 3
  s_sub_u32 s64, s64, s66
  s_cmp_eq_u32 s64, 2
  s_cselect_b32 s64, 4, s64
  s_mul_i32 s65, s65, 7
  s_add_u32 s64, s64, s65
  s_add_u32 s64, s64, 2
  s_lshl_b32 s62, s64, 12
  s_add_u32 s62, s62, 32768
  s_add_u32 s62, s62, s82
  s_add_u32 m0, s96, 0
  s_nop 0
  buffer_load_dwordx4 v12, s[44:47], s62 offen sc1 lds
  buffer_load_dwordx4 v12, s[44:47], s62 offen offset:1024 sc1 lds
  buffer_load_dwordx4 v12, s[44:47], s62 offen offset:2048 sc1 lds
  buffer_load_dwordx4 v12, s[44:47], s62 offen offset:3072 sc1 lds
  s_add_u32 s64, s92, 2
  s_and_b32 s64, s64, 7
  s_mul_i32 s62, s64, 50176
  s_add_u32 s62, s62, s69
  s_add_u32 m0, s96, 65536
  s_nop 0
  buffer_load_dwordx4 v18, s[40:43], s62 offen lds
  buffer_load_dwordx4 v19, s[40:43], s62 offen offset:1024 lds
  buffer_load_dwordx4 v20, s[40:43], s62 offen offset:2048 lds
  buffer_load_dwordx4 v21, s[40:43], s62 offen offset:3072 lds
  s_waitcnt vmcnt(12)
  s_barrier
  s_add_u32 s64, s92, 10
  s_cmp_ge_u32 s64, 12
  s_cselect_b32 s65, 12, 0
  s_sub_u32 s64, s64, s65
  s_cmp_ge_u32 s64, 12
  s_cselect_b32 s65, 12, 0
  s_sub_u32 s64, s64, s65
  s_mul_i32 s65, s64, 43
  s_lshr_b32 s65, s65, 7
  s_mul_i32 s66, s65, 3
  s_sub_u32 s64, s64, s66
  s_cmp_eq_u32 s64, 2
  s_cselect_b32 s64, 4, s64
  s_mul_i32 s65, s65, 7
  s_add_u32 s64, s64, s65
  s_add_u32 s64, s64, 2
  s_lshl_b32 s62, s64, 12
  s_add_u32 s62, s62, 32768
  s_add_u32 s62, s62, s82
  s_add_u32 m0, s96, 16384
  s_nop 0
  buffer_load_dwordx4 v12, s[44:47], s62 offen sc1 lds
  buffer_load_dwordx4 v12, s[44:47], s62 offen offset:1024 sc1 lds
  buffer_load_dwordx4 v12, s[44:47], s62 offen offset:2048 sc1 lds
  buffer_load_dwordx4 v12, s[44:47], s62 offen offset:3072 sc1 lds
  s_add_u32 s64, s92, 4
  s_and_b32 s64, s64, 7
  s_mul_i32 s62, s64, 50176
  s_add_u32 s62, s62, s69
  s_add_u32 m0, s96, 114688
  s_nop 0
  buffer_load_dwordx4 v18, s[40:43], s62 offen lds
  buffer_load_dwordx4 v19, s[40:43], s62 offen offset:1024 lds
  buffer_load_dwordx4 v20, s[40:43], s62 offen offset:2048 lds
  buffer_load_dwordx4 v21, s[40:43], s62 offen offset:3072 lds
  s_waitcnt vmcnt(12)
  s_barrier
  s_add_u32 s64, s92, 0
  s_and_b32 s64, s64, 7
  s_lshl_b32 s62, s64, 12
  s_add_u32 s62, s62, s82
  s_add_u32 m0, s96, 32768
  s_nop 0
  buffer_load_dwordx4 v12, s[44:47], s62 offen sc1 lds
  buffer_load_dwordx4 v12, s[44:47], s62 offen offset:1024 sc1 lds
  buffer_load_dwordx4 v12, s[44:47], s62 offen offset:2048 sc1 lds
  buffer_load_dwordx4 v12, s[44:47], s62 offen offset:3072 sc1 lds
  s_add_u32 s64, s92, 6
  s_and_b32 s64, s64, 7
  s_mul_i32 s62, s64, 50176
  s_add_u32 s62, s62, s69
  s_add_u32 m0, s96, 98304
  s_nop 0
  buffer_load_dwordx4 v18, s[40:43], s62 offen lds
  buffer_load_dwordx4 v19, s[40:43], s62 offen offset:1024 lds
  buffer_load_dwordx4 v20, s[40:43], s62 offen offset:2048 lds
  buffer_load_dwordx4 v21, s[40:43], s62 offen offset:3072 lds
  s_waitcnt vmcnt(12)
  s_barrier
  s_add_u32 s64, s92, 2
  s_and_b32 s64, s64, 7
  s_lshl_b32 s62, s64, 12
  s_add_u32 s62, s62, s82
  s_add_u32 m0, s96, 0
  s_nop 0
  buffer_load_dwordx4 v12, s[44:47], s62 offen sc1 lds
  buffer_load_dwordx4 v12, s[44:47], s62 offen offset:1024 sc1 lds
  buffer_load_dwordx4 v12, s[44:47], s62 offen offset:2048 sc1 lds
  buffer_load_dwordx4 v12, s[44:47], s62 offen offset:3072 sc1 lds
  s_waitcnt vmcnt(8)
  s_barrier
  s_add_u32 s64, s92, 4
  s_and_b32 s64, s64, 7
  s_lshl_b32 s62, s64, 12
  s_add_u32 s62, s62, s82
  s_add_u32 m0, s96, 16384
  s_nop 0
  buffer_load_dwordx4 v12, s[44:47], s62 offen sc1 lds
  buffer_load_dwordx4 v12, s[44:47], s62 offen offset:1024 sc1 lds
  buffer_load_dwordx4 v12, s[44:47], s62 offen offset:2048 sc1 lds
  buffer_load_dwordx4 v12, s[44:47], s62 offen offset:3072 sc1 lds
  s_waitcnt vmcnt(4)
  s_barrier
  s_add_u32 s64, s92, 6
  s_and_b32 s64, s64, 7
  s_lshl_b32 s62, s64, 12
  s_add_u32 s62, s62, s82
  s_add_u32 m0, s96, 32768
  s_nop 0
  buffer_load_dwordx4 v12, s[44:47], s62 offen sc1 lds
  buffer_load_dwordx4 v12, s[44:47], s62 offen offset:1024 sc1 lds
  buffer_load_dwordx4 v12, s[44:47], s62 offen offset:2048 sc1 lds
  buffer_load_dwordx4 v12, s[44:47], s62 offen offset:3072 sc1 lds
  s_waitcnt vmcnt(4)
  s_barrier
  s_waitcnt vmcnt(0)
  s_barrier
  s_branch L_fin
L_idleB:
  buffer_load_dwordx2 v[16:17], v13, s[44:47], s89 offen offset:128 sc1
  s_waitcnt vmcnt(0)
  s_mov_b32 s84, 65536
  s_branch L_pchk_31
L_poll_29:
  s_sleep 1
  buffer_load_dwordx2 v[16:17], v13, s[44:47], s89 offen offset:128 sc1
  s_waitcnt vmcnt(0)
L_pchk_31:
  v_cmp_eq_u64 vcc, s[60:61], v[16:17]
  s_and_b32 s64, vcc_lo, 65535
  s_cmp_eq_u32 s64, 65535
  s_cbranch_scc1 L_pok_30
  s_sub_u32 s84, s84, 1
  s_cmp_lg_u32 s84, 0
  s_cbranch_scc1 L_poll_29
L_pok_30:
  s_lshl_b32 s62, s54, 13
  s_lshl_b32 s63, s59, 11
  s_add_u32 s62, s62, s63
  s_add_u32 s62, s62, 16777216
  s_add_u32 m0, s63, 57344
  s_nop 0
  buffer_load_dwordx4 v12, s[44:47], s62 offen sc1 lds
  buffer_load_dwordx4 v12, s[44:47], s62 offen offset:1024 sc1 lds
L_idleA:
  s_waitcnt vmcnt(0)
  s_barrier
  s_lshl_b32 s62, s93, 12
  s_add_u32 s62, s62, 57344
  v_lshl_add_u32 v112, v1, 2, s62
  ds_read2st64_b32 v[96:97], v112 offset0:0 offset1:1
  ds_read2st64_b32 v[98:99], v112 offset0:2 offset1:3
  ds_read2st64_b32 v[100:101], v112 offset0:4 offset1:5
  s_waitcnt lgkmcnt(3)
  ds_read2st64_b32 v[102:103], v112 offset0:6 offset1:7
  ds_read2st64_b32 v[104:105], v112 offset0:8 offset1:9
  ds_read2st64_b32 v[106:107], v112 offset0:10 offset1:11
  ds_read2st64_b32 v[108:109], v112 offset0:12 offset1:13
  ds_read2st64_b32 v[110:111], v112 offset0:14 offset1:15
  s_waitcnt lgkmcnt(0)
  v_cvt_pk_bf16_f32 v112, v96, v97
  v_cvt_pk_bf16_f32 v113, v98, v99
  v_cvt_pk_bf16_f32 v114, v100, v101
  v_cvt_pk_bf16_f32 v115, v102, v103
  v_cvt_pk_bf16_f32 v116, v104, v105
  v_cvt_pk_bf16_f32 v117, v106, v107
  v_cvt_pk_bf16_f32 v118, v108, v109
  v_cvt_pk_bf16_f32 v119, v110, v111
  s_nop 1
  v_mfma_f32_32x32x16_bf16 v[96:111], v[112:115], v[120:123], 0
  v_mfma_f32_32x32x16_bf16 v[96:111], v[116:119], v[124:127], v[96:111]
  s_lshl_b32 s63, s53, 2
  s_add_u32 s63, s63, s59
  s_mul_i32 s63, s63, 147456
  s_lshl_b32 s62, s54, 1
  s_add_u32 s62, s62, s93
  s_lshl_b32 s62, s62, 11
  s_add_u32 s62, s62, s63
  s_nop 5
  v_mov_b32 v112, v108
  v_mov_b32 v113, v108
  s_nop 1
  v_permlane32_swap_b32 v112, v113
  s_nop 1
  v_add_f32 v113, s86, v113
  v_rcp_f32 v113, v113
  s_nop 0
  v_mul_f32 v96, v96, v113
  v_mul_f32 v97, v97, v113
  v_mul_f32 v98, v98, v113
  v_mul_f32 v99, v99, v113
  v_mul_f32 v100, v100, v113
  v_mul_f32 v101, v101, v113
  v_mul_f32 v102, v102, v113
  v_mul_f32 v103, v103, v113
  v_mul_f32 v104, v104, v113
  v_mul_f32 v105, v105, v113
  v_mul_f32 v106, v106, v113
  v_mul_f32 v107, v107, v113
  v_mul_f32 v108, v108, v113
  v_mul_f32 v109, v109, v113
  v_mul_f32 v110, v110, v113
  v_mul_f32 v111, v111, v113
  v_cvt_pk_bf16_f32 v120, v96, v97
  v_cvt_pk_bf16_f32 v121, v98, v99
  v_cvt_pk_bf16_f32 v122, v100, v101
  v_cvt_pk_bf16_f32 v123, v102, v103
  v_cvt_pk_bf16_f32 v124, v104, v105
  v_cvt_pk_bf16_f32 v125, v106, v107
  v_cvt_pk_bf16_f32 v126, v108, v109
  v_cvt_pk_bf16_f32 v127, v110, v111
  s_mov_b32 exec_lo, 0
  v_mov_b32 v126, 0
  v_mov_b32 v127, 0
  s_mov_b64 exec, -1
  buffer_store_dwordx4 v[120:123], v12, s[44:47], s62 offen sc0 sc1
  buffer_store_dwordx4 v[124:127], v12, s[44:47], s62 offen offset:1024 sc0 sc1
  s_waitcnt vmcnt(0)
  s_barrier
  s_cmp_lg_u32 s52, 0
  s_cbranch_scc1 L_skip_32
  s_lshl_b32 s62, s53, 9
  s_lshl_b32 s63, s58, 3
  s_add_u32 s62, s62, s63
  s_add_u32 s62, s62, 16853248
  v_mov_b32 v24, s60
  v_mov_b32 v25, s61
  s_mov_b64 exec, 1
  buffer_store_dwordx2 v[24:25], v22, s[44:47], s62 offen sc0 sc1
  s_mov_b64 exec, -1
L_skip_32:
  s_branch L_fin
L_cons:
  s_barrier
  ds_read_b64_tr_b16 a[0:1], v28 offset:32768
  ds_read_b64_tr_b16 a[2:3], v28 offset:33792
  ds_read_b128 a[4:7], v26 offset:0
  ds_read_b64_tr_b16 a[8:9], v28 offset:34816
  ds_read_b64_tr_b16 a[10:11], v28 offset:35840
  ds_read_b128 a[12:15], v26 offset:1024
  ds_read_b64_tr_b16 a[16:17], v28 offset:36864
  ds_read_b64_tr_b16 a[18:19], v28 offset:37888
  ds_read_b128 a[20:23], v26 offset:2048
  ds_read_b64_tr_b16 a[24:25], v28 offset:38912
  ds_read_b64_tr_b16 a[26:27], v28 offset:39936
  ds_read_b128 a[28:31], v26 offset:3072
  s_waitcnt lgkmcnt(9)
  v_mfma_f32_32x32x16_bf16 v[48:63], a[0:3], a[4:7], 0
  ds_read_b64_tr_b16 a[32:33], v28 offset:40960
  ds_read_b64_tr_b16 a[34:35], v28 offset:41984
  ds_read_b128 a[36:39], v26 offset:8192
  s_waitcnt lgkmcnt(9)
  v_mfma_f32_32x32x16_bf16 v[48:63], a[8:11], a[12:15], v[48:63]
  ds_read_b64_tr_b16 a[40:41], v28 offset:43008
  ds_read_b64_tr_b16 a[42:43], v28 offset:44032
  ds_read_b128 a[44:47], v26 offset:9216
  s_waitcnt lgkmcnt(9)
  v_mfma_f32_32x32x16_bf16 v[48:63], a[16:19], a[20:23], v[48:63]
  ds_read_b64_tr_b16 a[48:49], v28 offset:45056
  ds_read_b64_tr_b16 a[50:51], v28 offset:46080
  ds_read_b128 a[52:55], v26 offset:10240
  s_waitcnt lgkmcnt(9)
  v_mfma_f32_32x32x16_bf16 v[48:63], a[24:27], a[28:31], v[48:63]
  ds_read_b64_tr_b16 a[56:57], v28 offset:47104
  ds_read_b64_tr_b16 a[58:59], v28 offset:48128
  ds_read_b128 a[60:63], v26 offset:11264
  s_waitcnt lgkmcnt(9)
  v_mfma_f32_32x32x16_bf16 v[48:63], a[32:35], a[36:39], v[48:63]
  s_waitcnt lgkmcnt(6)
  v_mfma_f32_32x32x16_bf16 v[48:63], a[40:43], a[44:47], v[48:63]
  s_waitcnt lgkmcnt(0)
  s_barrier
  s_cmp_lg_u32 s52, 0
  s_cbranch_scc1 L_skip_33
  buffer_load_dwordx2 v[16:17], v13, s[44:47], s83 offen offset:128 sc1
L_skip_33:
  s_cmp_ge_u32 s58, 8
  s_cbranch_scc1 L_skip_34
  s_cmp_lg_u32 s52, 1
  s_cbranch_scc1 L_skip_35
  buffer_load_dwordx2 v[16:17], v13, s[44:47], s89 offen offset:128 sc1
L_skip_35:
L_skip_34:
  ds_read_b64_tr_b16 a[0:1], v28 offset:16384
  ds_read_b64_tr_b16 a[2:3], v28 offset:17408
  ds_read_b128 a[4:7], v26 offset:16384
  ds_read_b64_tr_b16 a[8:9], v28 offset:18432
  ds_read_b64_tr_b16 a[10:11], v28 offset:19456
  ds_read_b128 a[12:15], v26 offset:17408
  v_mfma_f32_32x32x16_bf16 v[48:63], a[48:51], a[52:55], v[48:63]
  ds_read_b64_tr_b16 a[16:17], v28 offset:20480
  ds_read_b64_tr_b16 a[18:19], v28 offset:21504
  ds_read_b128 a[20:23], v26 offset:18432
  v_mfma_f32_32x32x16_bf16 v[48:63], a[56:59], a[60:63], v[48:63]
  ds_read_b64_tr_b16 a[24:25], v28 offset:22528
  ds_read_b64_tr_b16 a[26:27], v28 offset:23552
  ds_read_b128 a[28:31], v26 offset:19456
  s_waitcnt lgkmcnt(9)
  v_mfma_f32_32x32x16_bf16 v[48:63], a[0:3], a[4:7], v[48:63]
  ds_read_b64_tr_b16 a[32:33], v28 offset:24576
  ds_read_b64_tr_b16 a[34:35], v28 offset:25600
  ds_read_b128 a[36:39], v26 offset:24576
  s_waitcnt lgkmcnt(9)
  v_mfma_f32_32x32x16_bf16 v[48:63], a[8:11], a[12:15], v[48:63]
  ds_read_b64_tr_b16 a[40:41], v28 offset:26624
  ds_read_b64_tr_b16 a[42:43], v28 offset:27648
  ds_read_b128 a[44:47], v26 offset:25600
  s_waitcnt lgkmcnt(9)
  v_mfma_f32_32x32x16_bf16 v[48:63], a[16:19], a[20:23], v[48:63]
  ds_read_b64_tr_b16 a[48:49], v28 offset:28672
  ds_read_b64_tr_b16 a[50:51], v28 offset:29696
  ds_read_b128 a[52:55], v26 offset:26624
  s_waitcnt lgkmcnt(9)
  v_mfma_f32_32x32x16_bf16 v[48:63], a[24:27], a[28:31], v[48:63]
  ds_read_b64_tr_b16 a[56:57], v28 offset:30720
  ds_read_b64_tr_b16 a[58:59], v28 offset:31744
  ds_read_b128 a[60:63], v26 offset:27648
  s_waitcnt lgkmcnt(9)
  v_mfma_f32_32x32x16_bf16 v[48:63], a[32:35], a[36:39], v[48:63]
  s_waitcnt lgkmcnt(6)
  v_mfma_f32_32x32x16_bf16 v[48:63], a[40:43], a[44:47], v[48:63]
  s_cmp_lg_u32 s52, 0
  s_cbranch_scc1 L_skip_36
  s_waitcnt vmcnt(0)
  s_mov_b32 s84, 65536
  s_branch L_pchk_39
L_poll_37:
  s_sleep 1
  buffer_load_dwordx2 v[16:17], v13, s[44:47], s83 offen offset:128 sc1
  s_waitcnt vmcnt(0)
L_pchk_39:
  v_cmp_eq_u64 vcc, s[60:61], v[16:17]
  s_and_b32 s64, vcc_lo, 65280
  s_cmp_eq_u32 s64, 65280
  s_cbranch_scc1 L_pok_38
  s_sub_u32 s84, s84, 1
  s_cmp_lg_u32 s84, 0
  s_cbranch_scc1 L_poll_37
L_pok_38:
L_skip_36:
  s_cmp_lt_u32 s58, 8
  s_cbranch_scc1 L_skip_40
  s_waitcnt vmcnt(0)
L_skip_40:
  s_waitcnt lgkmcnt(0)
  s_barrier
  s_cmp_lt_u32 s58, 8
  s_cbranch_scc1 L_skip_41
  s_cmp_lg_u32 s52, 0
  s_cbranch_scc1 L_skip_42
  s_lshl_b32 s62, s53, 9
  s_lshl_b32 s63, s58, 3
  s_add_u32 s62, s62, s63
  s_add_u32 s62, s62, 16853248
  v_mov_b32 v24, s60
  v_mov_b32 v25, s61
  s_mov_b64 exec, 1
  buffer_store_dwordx2 v[24:25], v22, s[44:47], s62 offen sc0 sc1
  s_mov_b64 exec, -1
L_skip_42:
L_skip_41:
  ds_read_b64_tr_b16 a[0:1], v27 offset:16384
  ds_read_b64_tr_b16 a[2:3], v27 offset:17408
  ds_read_b128 a[4:7], v26 offset:32768
  ds_read_b64_tr_b16 a[8:9], v27 offset:18432
  ds_read_b64_tr_b16 a[10:11], v27 offset:19456
  ds_read_b128 a[12:15], v26 offset:33792
  v_mfma_f32_32x32x16_bf16 v[48:63], a[48:51], a[52:55], v[48:63]
  ds_read_b64_tr_b16 a[16:17], v27 offset:20480
  ds_read_b64_tr_b16 a[18:19], v27 offset:21504
  ds_read_b128 a[20:23], v26 offset:34816
  v_mfma_f32_32x32x16_bf16 v[48:63], a[56:59], a[60:63], v[48:63]
  ds_read_b64_tr_b16 a[24:25], v27 offset:22528
  ds_read_b64_tr_b16 a[26:27], v27 offset:23552
  ds_read_b128 a[28:31], v26 offset:35840
  s_waitcnt lgkmcnt(9)
  v_mfma_f32_32x32x16_bf16 v[48:63], a[0:3], a[4:7], v[48:63]
  ds_read_b64_tr_b16 a[32:33], v27 offset:24576
  ds_read_b64_tr_b16 a[34:35], v27 offset:25600
  ds_read_b128 a[36:39], v26 offset:40960
  s_waitcnt lgkmcnt(9)
  v_mfma_f32_32x32x16_bf16 v[48:63], a[8:11], a[12:15], v[48:63]
  ds_read_b64_tr_b16 a[40:41], v27 offset:26624
  ds_read_b64_tr_b16 a[42:43], v27 offset:27648
  ds_read_b128 a[44:47], v26 offset:41984
  s_waitcnt lgkmcnt(9)
  v_mfma_f32_32x32x16_bf16 v[48:63], a[16:19], a[20:23], v[48:63]
  ds_read_b64_tr_b16 a[48:49], v27 offset:28672
  ds_read_b64_tr_b16 a[50:51], v27 offset:29696
  ds_read_b128 a[52:55], v26 offset:43008
  s_waitcnt lgkmcnt(9)
  v_mfma_f32_32x32x16_bf16 v[48:63], a[24:27], a[28:31], v[48:63]
  ds_read_b64_tr_b16 a[56:57], v27 offset:30720
  ds_read_b64_tr_b16 a[58:59], v27 offset:31744
  ds_read_b128 a[60:63], v26 offset:44032
  s_waitcnt lgkmcnt(9)
  v_mfma_f32_32x32x16_bf16 v[48:63], a[32:35], a[36:39], v[48:63]
  s_waitcnt lgkmcnt(6)
  v_mfma_f32_32x32x16_bf16 v[48:63], a[40:43], a[44:47], v[48:63]
  s_cmp_ge_u32 s58, 8
  s_cbranch_scc1 L_skip_43
  s_cmp_lg_u32 s52, 1
  s_cbranch_scc1 L_skip_44
  s_waitcnt vmcnt(0)
  s_mov_b32 s84, 65536
  s_branch L_pchk_47
L_poll_45:
  s_sleep 1
  buffer_load_dwordx2 v[16:17], v13, s[44:47], s89 offen offset:128 sc1
  s_waitcnt vmcnt(0)
L_pchk_47:
  v_cmp_eq_u64 vcc, s[60:61], v[16:17]
  s_and_b32 s64, vcc_lo, 65535
  s_cmp_eq_u32 s64, 65535
  s_cbranch_scc1 L_pok_46
  s_sub_u32 s84, s84, 1
  s_cmp_lg_u32 s84, 0
  s_cbranch_scc1 L_poll_45
L_pok_46:
L_skip_44:
L_skip_43:
  s_waitcnt lgkmcnt(0)
  s_barrier
  ds_read_b64_tr_b16 a[0:1], v27 offset:0
  ds_read_b64_tr_b16 a[2:3], v27 offset:1024
  ds_read_b128 a[4:7], v26 offset:0
  ds_read_b64_tr_b16 a[8:9], v27 offset:2048
  ds_read_b64_tr_b16 a[10:11], v27 offset:3072
  ds_read_b128 a[12:15], v26 offset:1024
  v_mfma_f32_32x32x16_bf16 v[48:63], a[48:51], a[52:55], v[48:63]
  ds_read_b64_tr_b16 a[16:17], v27 offset:4096
  ds_read_b64_tr_b16 a[18:19], v27 offset:5120
  ds_read_b128 a[20:23], v26 offset:2048
  v_mfma_f32_32x32x16_bf16 v[48:63], a[56:59], a[60:63], v[48:63]
  ds_read_b64_tr_b16 a[24:25], v27 offset:6144
  ds_read_b64_tr_b16 a[26:27], v27 offset:7168
  ds_read_b128 a[28:31], v26 offset:3072
  s_waitcnt lgkmcnt(9)
  v_mfma_f32_32x32x16_bf16 v[48:63], a[0:3], a[4:7], v[48:63]
  ds_read_b64_tr_b16 a[32:33], v27 offset:8192
  ds_read_b64_tr_b16 a[34:35], v27 offset:9216
  ds_read_b128 a[36:39], v26 offset:8192
  s_waitcnt lgkmcnt(9)
  v_mfma_f32_32x32x16_bf16 v[48:63], a[8:11], a[12:15], v[48:63]
  ds_read_b64_tr_b16 a[40:41], v27 offset:10240
  ds_read_b64_tr_b16 a[42:43], v27 offset:11264
  ds_read_b128 a[44:47], v26 offset:9216
  s_waitcnt lgkmcnt(9)
  v_mfma_f32_32x32x16_bf16 v[48:63], a[16:19], a[20:23], v[48:63]
  ds_read_b64_tr_b16 a[48:49], v27 offset:12288
  ds_read_b64_tr_b16 a[50:51], v27 offset:13312
  ds_read_b128 a[52:55], v26 offset:10240
  s_waitcnt lgkmcnt(9)
  v_mfma_f32_32x32x16_bf16 v[48:63], a[24:27], a[28:31], v[48:63]
  ds_read_b64_tr_b16 a[56:57], v27 offset:14336
  ds_read_b64_tr_b16 a[58:59], v27 offset:15360
  ds_read_b128 a[60:63], v26 offset:11264
  s_waitcnt lgkmcnt(9)
  v_mfma_f32_32x32x16_bf16 v[48:63], a[32:35], a[36:39], v[48:63]
  s_waitcnt lgkmcnt(6)
  v_mfma_f32_32x32x16_bf16 v[48:63], a[40:43], a[44:47], v[48:63]
  s_waitcnt lgkmcnt(0)
  s_barrier
  ds_read_b64_tr_b16 a[0:1], v28 offset:0
  ds_read_b64_tr_b16 a[2:3], v28 offset:1024
  ds_read_b128 a[4:7], v26 offset:16384
  ds_read_b64_tr_b16 a[8:9], v28 offset:2048
  ds_read_b64_tr_b16 a[10:11], v28 offset:3072
  ds_read_b128 a[12:15], v26 offset:17408
  v_mfma_f32_32x32x16_bf16 v[48:63], a[48:51], a[52:55], v[48:63]
  ds_read_b64_tr_b16 a[16:17], v28 offset:4096
  ds_read_b64_tr_b16 a[18:19], v28 offset:5120
  ds_read_b128 a[20:23], v26 offset:18432
  v_mfma_f32_32x32x16_bf16 v[48:63], a[56:59], a[60:63], v[48:63]
  ds_read_b64_tr_b16 a[24:25], v28 offset:6144
  ds_read_b64_tr_b16 a[26:27], v28 offset:7168
  ds_read_b128 a[28:31], v26 offset:19456
  s_waitcnt lgkmcnt(9)
  v_mfma_f32_32x32x16_bf16 v[48:63], a[0:3], a[4:7], v[48:63]
  ds_read_b64_tr_b16 a[32:33], v28 offset:8192
  ds_read_b64_tr_b16 a[34:35], v28 offset:9216
  ds_read_b128 a[36:39], v26 offset:24576
  s_waitcnt lgkmcnt(9)
  v_mfma_f32_32x32x16_bf16 v[48:63], a[8:11], a[12:15], v[48:63]
  ds_read_b64_tr_b16 a[40:41], v28 offset:10240
  ds_read_b64_tr_b16 a[42:43], v28 offset:11264
  ds_read_b128 a[44:47], v26 offset:25600
  s_waitcnt lgkmcnt(9)
  v_mfma_f32_32x32x16_bf16 v[48:63], a[16:19], a[20:23], v[48:63]
  ds_read_b64_tr_b16 a[48:49], v28 offset:12288
  ds_read_b64_tr_b16 a[50:51], v28 offset:13312
  ds_read_b128 a[52:55], v26 offset:26624
  s_waitcnt lgkmcnt(9)
  v_mfma_f32_32x32x16_bf16 v[48:63], a[24:27], a[28:31], v[48:63]
  ds_read_b64_tr_b16 a[56:57], v28 offset:14336
  ds_read_b64_tr_b16 a[58:59], v28 offset:15360
  ds_read_b128 a[60:63], v26 offset:27648
  s_waitcnt lgkmcnt(9)
  v_mfma_f32_32x32x16_bf16 v[48:63], a[32:35], a[36:39], v[48:63]
  s_waitcnt lgkmcnt(6)
  v_mfma_f32_32x32x16_bf16 v[48:63], a[40:43], a[44:47], v[48:63]
  s_waitcnt lgkmcnt(0)
  s_barrier
  s_cmp_lg_u32 s52, 0
  s_cbranch_scc1 L_skip_48
  buffer_load_dwordx2 v[16:17], v13, s[44:47], s83 offen offset:256 sc1
L_skip_48:
  ds_read_b64_tr_b16 a[0:1], v27 offset:32768
  ds_read_b64_tr_b16 a[2:3], v27 offset:33792
  ds_read_b128 a[4:7], v26 offset:32768
  ds_read_b64_tr_b16 a[8:9], v27 offset:34816
  ds_read_b64_tr_b16 a[10:11], v27 offset:35840
  ds_read_b128 a[12:15], v26 offset:33792
  v_mfma_f32_32x32x16_bf16 v[48:63], a[48:51], a[52:55], v[48:63]
  ds_read_b64_tr_b16 a[16:17], v27 offset:36864
  ds_read_b64_tr_b16 a[18:19], v27 offset:37888
  ds_read_b128 a[20:23], v26 offset:34816
  v_mfma_f32_32x32x16_bf16 v[48:63], a[56:59], a[60:63], v[48:63]
  ds_read_b64_tr_b16 a[24:25], v27 offset:38912
  ds_read_b64_tr_b16 a[26:27], v27 offset:39936
  ds_read_b128 a[28:31], v26 offset:35840
  s_waitcnt lgkmcnt(9)
  v_mfma_f32_32x32x16_bf16 v[48:63], a[0:3], a[4:7], v[48:63]
  ds_read_b64_tr_b16 a[32:33], v27 offset:40960
  ds_read_b64_tr_b16 a[34:35], v27 offset:41984
  ds_read_b128 a[36:39], v26 offset:40960
  s_cmp_ge_u32 s58, 8
  s_cbranch_scc1 L_skip_49
  s_lshl_b32 s62, s93, 12
  s_add_u32 s62, s62, 57344
  v_lshl_add_u32 v112, v1, 2, s62
  ds_read2st64_b32 v[96:97], v112 offset0:0 offset1:1
  ds_read2st64_b32 v[98:99], v112 offset0:2 offset1:3
  ds_read2st64_b32 v[100:101], v112 offset0:4 offset1:5
  s_waitcnt lgkmcnt(3)
  ds_read2st64_b32 v[102:103], v112 offset0:6 offset1:7
  ds_read2st64_b32 v[104:105], v112 offset0:8 offset1:9
  ds_read2st64_b32 v[106:107], v112 offset0:10 offset1:11
  ds_read2st64_b32 v[108:109], v112 offset0:12 offset1:13
  ds_read2st64_b32 v[110:111], v112 offset0:14 offset1:15
  s_waitcnt lgkmcnt(0)
  v_cvt_pk_bf16_f32 v112, v96, v97
  v_cvt_pk_bf16_f32 v113, v98, v99
  v_cvt_pk_bf16_f32 v114, v100, v101
  v_cvt_pk_bf16_f32 v115, v102, v103
  v_cvt_pk_bf16_f32 v116, v104, v105
  v_cvt_pk_bf16_f32 v117, v106, v107
  v_cvt_pk_bf16_f32 v118, v108, v109
  v_cvt_pk_bf16_f32 v119, v110, v111
  s_nop 1
  v_mfma_f32_32x32x16_bf16 v[96:111], v[112:115], v[120:123], 0
  v_mfma_f32_32x32x16_bf16 v[96:111], v[116:119], v[124:127], v[96:111]
  s_lshl_b32 s63, s53, 2
  s_add_u32 s63, s63, s59
  s_mul_i32 s63, s63, 147456
  s_lshl_b32 s62, s54, 1
  s_add_u32 s62, s62, s93
  s_lshl_b32 s62, s62, 11
  s_add_u32 s62, s62, s63
  s_nop 5
  v_mov_b32 v112, v108
  v_mov_b32 v113, v108
  s_nop 1
  v_permlane32_swap_b32 v112, v113
  s_nop 1
  v_add_f32 v113, s86, v113
  v_rcp_f32 v113, v113
  s_nop 0
  v_mul_f32 v96, v96, v113
  v_mul_f32 v97, v97, v113
  v_mul_f32 v98, v98, v113
  v_mul_f32 v99, v99, v113
  v_mul_f32 v100, v100, v113
  v_mul_f32 v101, v101, v113
  v_mul_f32 v102, v102, v113
  v_mul_f32 v103, v103, v113
  v_mul_f32 v104, v104, v113
  v_mul_f32 v105, v105, v113
  v_mul_f32 v106, v106, v113
  v_mul_f32 v107, v107, v113
  v_mul_f32 v108, v108, v113
  v_mul_f32 v109, v109, v113
  v_mul_f32 v110, v110, v113
  v_mul_f32 v111, v111, v113
  v_cvt_pk_bf16_f32 v120, v96, v97
  v_cvt_pk_bf16_f32 v121, v98, v99
  v_cvt_pk_bf16_f32 v122, v100, v101
  v_cvt_pk_bf16_f32 v123, v102, v103
  v_cvt_pk_bf16_f32 v124, v104, v105
  v_cvt_pk_bf16_f32 v125, v106, v107
  v_cvt_pk_bf16_f32 v126, v108, v109
  v_cvt_pk_bf16_f32 v127, v110, v111
  s_mov_b32 exec_lo, 0
  v_mov_b32 v126, 0
  v_mov_b32 v127, 0
  s_mov_b64 exec, -1
  buffer_store_dwordx4 v[120:123], v12, s[44:47], s62 offen sc0 sc1
  buffer_store_dwordx4 v[124:127], v12, s[44:47], s62 offen offset:1024 sc0 sc1
L_skip_49:
  s_waitcnt lgkmcnt(9)
  v_mfma_f32_32x32x16_bf16 v[48:63], a[8:11], a[12:15], v[48:63]
  ds_read_b64_tr_b16 a[40:41], v27 offset:43008
  ds_read_b64_tr_b16 a[42:43], v27 offset:44032
  ds_read_b128 a[44:47], v26 offset:41984
  s_waitcnt lgkmcnt(9)
  v_mfma_f32_32x32x16_bf16 v[48:63], a[16:19], a[20:23], v[48:63]
  ds_read_b64_tr_b16 a[48:49], v27 offset:45056
  ds_read_b64_tr_b16 a[50:51], v27 offset:46080
  ds_read_b128 a[52:55], v26 offset:43008
  s_waitcnt lgkmcnt(9)
  v_mfma_f32_32x32x16_bf16 v[48:63], a[24:27], a[28:31], v[48:63]
  ds_read_b64_tr_b16 a[56:57], v27 offset:47104
  ds_read_b64_tr_b16 a[58:59], v27 offset:48128
  ds_read_b128 a[60:63], v26 offset:44032
  s_waitcnt lgkmcnt(9)
  v_mfma_f32_32x32x16_bf16 v[48:63], a[32:35], a[36:39], v[48:63]
  s_waitcnt lgkmcnt(6)
  v_mfma_f32_32x32x16_bf16 v[48:63], a[40:43], a[44:47], v[48:63]
  s_cmp_lg_u32 s52, 0
  s_cbranch_scc1 L_skip_50
  s_waitcnt vmcnt(0)
  s_mov_b32 s84, 65536
  s_branch L_pchk_53
L_poll_51:
  s_sleep 1
  buffer_load_dwordx2 v[16:17], v13, s[44:47], s83 offen offset:256 sc1
  s_waitcnt vmcnt(0)
L_pchk_53:
  v_cmp_eq_u64 vcc, s[60:61], v[16:17]
  s_and_b32 s64, vcc_lo, 65280
  s_cmp_eq_u32 s64, 65280
  s_cbranch_scc1 L_pok_52
  s_sub_u32 s84, s84, 1
  s_cmp_lg_u32 s84, 0
  s_cbranch_scc1 L_poll_51
L_pok_52:
L_skip_50:
  s_waitcnt lgkmcnt(0)
  s_barrier
  ds_read_b64_tr_b16 a[0:1], v28 offset:32768
  ds_read_b64_tr_b16 a[2:3], v28 offset:33792
  ds_read_b128 a[4:7], v26 offset:0
  ds_read_b64_tr_b16 a[8:9], v28 offset:34816
  ds_read_b64_tr_b16 a[10:11], v28 offset:35840
  ds_read_b128 a[12:15], v26 offset:1024
  v_mfma_f32_32x32x16_bf16 v[48:63], a[48:51], a[52:55], v[48:63]
  ds_read_b64_tr_b16 a[16:17], v28 offset:36864
  ds_read_b64_tr_b16 a[18:19], v28 offset:37888
  ds_read_b128 a[20:23], v26 offset:2048
  v_mfma_f32_32x32x16_bf16 v[48:63], a[56:59], a[60:63], v[48:63]
  ds_read_b64_tr_b16 a[24:25], v28 offset:38912
  ds_read_b64_tr_b16 a[26:27], v28 offset:39936
  ds_read_b128 a[28:31], v26 offset:3072
  s_waitcnt lgkmcnt(9)
  v_mfma_f32_32x32x16_bf16 v[48:63], a[0:3], a[4:7], v[48:63]
  ds_read_b64_tr_b16 a[32:33], v28 offset:40960
  ds_read_b64_tr_b16 a[34:35], v28 offset:41984
  ds_read_b128 a[36:39], v26 offset:8192
  s_waitcnt lgkmcnt(9)
  v_mfma_f32_32x32x16_bf16 v[48:63], a[8:11], a[12:15], v[48:63]
  ds_read_b64_tr_b16 a[40:41], v28 offset:43008
  ds_read_b64_tr_b16 a[42:43], v28 offset:44032
  ds_read_b128 a[44:47], v26 offset:9216
  s_waitcnt lgkmcnt(9)
  v_mfma_f32_32x32x16_bf16 v[48:63], a[16:19], a[20:23], v[48:63]
  ds_read_b64_tr_b16 a[48:49], v28 offset:45056
  ds_read_b64_tr_b16 a[50:51], v28 offset:46080
  ds_read_b128 a[52:55], v26 offset:10240
  s_waitcnt lgkmcnt(9)
  v_mfma_f32_32x32x16_bf16 v[48:63], a[24:27], a[28:31], v[48:63]
  ds_read_b64_tr_b16 a[56:57], v28 offset:47104
  ds_read_b64_tr_b16 a[58:59], v28 offset:48128
  ds_read_b128 a[60:63], v26 offset:11264
  s_waitcnt lgkmcnt(9)
  v_mfma_f32_32x32x16_bf16 v[48:63], a[32:35], a[36:39], v[48:63]
  s_waitcnt lgkmcnt(6)
  v_mfma_f32_32x32x16_bf16 v[48:63], a[40:43], a[44:47], v[48:63]
  s_waitcnt vmcnt(0)
  s_waitcnt lgkmcnt(0)
  s_barrier
  s_cmp_ge_u32 s58, 8
  s_cbranch_scc1 L_skip_54
  s_cmp_lg_u32 s52, 0
  s_cbranch_scc1 L_skip_55
  s_lshl_b32 s62, s53, 9
  s_lshl_b32 s63, s58, 3
  s_add_u32 s62, s62, s63
  s_add_u32 s62, s62, 16853248
  v_mov_b32 v24, s60
  v_mov_b32 v25, s61
  s_mov_b64 exec, 1
  buffer_store_dwordx2 v[24:25], v22, s[44:47], s62 offen sc0 sc1
  s_mov_b64 exec, -1
L_skip_55:
L_skip_54:
  ds_read_b64_tr_b16 a[0:1], v28 offset:16384
  ds_read_b64_tr_b16 a[2:3], v28 offset:17408
  ds_read_b128 a[4:7], v26 offset:16384
  ds_read_b64_tr_b16 a[8:9], v28 offset:18432
  ds_read_b64_tr_b16 a[10:11], v28 offset:19456
  ds_read_b128 a[12:15], v26 offset:17408
  v_mfma_f32_32x32x16_bf16 v[48:63], a[48:51], a[52:55], v[48:63]
  ds_read_b64_tr_b16 a[16:17], v28 offset:20480
  ds_read_b64_tr_b16 a[18:19], v28 offset:21504
  ds_read_b128 a[20:23], v26 offset:18432
  v_mfma_f32_32x32x16_bf16 v[48:63], a[56:59], a[60:63], v[48:63]
  ds_read_b64_tr_b16 a[24:25], v28 offset:22528
  ds_read_b64_tr_b16 a[26:27], v28 offset:23552
  ds_read_b128 a[28:31], v26 offset:19456
  s_waitcnt lgkmcnt(9)
  v_mfma_f32_32x32x16_bf16 v[48:63], a[0:3], a[4:7], v[48:63]
  ds_read_b64_tr_b16 a[32:33], v28 offset:24576
  ds_read_b64_tr_b16 a[34:35], v28 offset:25600
  ds_read_b128 a[36:39], v26 offset:24576
  s_waitcnt lgkmcnt(9)
  v_mfma_f32_32x32x16_bf16 v[48:63], a[8:11], a[12:15], v[48:63]
  ds_read_b64_tr_b16 a[40:41], v28 offset:26624
  ds_read_b64_tr_b16 a[42:43], v28 offset:27648
  ds_read_b128 a[44:47], v26 offset:25600
  s_waitcnt lgkmcnt(9)
  v_mfma_f32_32x32x16_bf16 v[48:63], a[16:19], a[20:23], v[48:63]
  ds_read_b64_tr_b16 a[48:49], v28 offset:28672
  ds_read_b64_tr_b16 a[50:51], v28 offset:29696
  ds_read_b128 a[52:55], v26 offset:26624
  s_waitcnt lgkmcnt(9)
  v_mfma_f32_32x32x16_bf16 v[48:63], a[24:27], a[28:31], v[48:63]
  ds_read_b64_tr_b16 a[56:57], v28 offset:30720
  ds_read_b64_tr_b16 a[58:59], v28 offset:31744
  ds_read_b128 a[60:63], v26 offset:27648
  s_waitcnt lgkmcnt(9)
  v_mfma_f32_32x32x16_bf16 v[48:63], a[32:35], a[36:39], v[48:63]
  s_waitcnt lgkmcnt(6)
  v_mfma_f32_32x32x16_bf16 v[48:63], a[40:43], a[44:47], v[48:63]
  s_waitcnt lgkmcnt(0)
  s_barrier
  ds_read_b64_tr_b16 a[0:1], v27 offset:16384
  ds_read_b64_tr_b16 a[2:3], v27 offset:17408
  ds_read_b128 a[4:7], v26 offset:32768
  ds_read_b64_tr_b16 a[8:9], v27 offset:18432
  ds_read_b64_tr_b16 a[10:11], v27 offset:19456
  ds_read_b128 a[12:15], v26 offset:33792
  v_mfma_f32_32x32x16_bf16 v[48:63], a[48:51], a[52:55], v[48:63]
  ds_read_b64_tr_b16 a[16:17], v27 offset:20480
  ds_read_b64_tr_b16 a[18:19], v27 offset:21504
  ds_read_b128 a[20:23], v26 offset:34816
  v_mfma_f32_32x32x16_bf16 v[48:63], a[56:59], a[60:63], v[48:63]
  ds_read_b64_tr_b16 a[24:25], v27 offset:22528
  ds_read_b64_tr_b16 a[26:27], v27 offset:23552
  ds_read_b128 a[28:31], v26 offset:35840
  s_waitcnt lgkmcnt(9)
  v_mfma_f32_32x32x16_bf16 v[48:63], a[0:3], a[4:7], v[48:63]
  ds_read_b64_tr_b16 a[32:33], v27 offset:24576
  ds_read_b64_tr_b16 a[34:35], v27 offset:25600
  ds_read_b128 a[36:39], v26 offset:40960
  s_waitcnt lgkmcnt(9)
  v_mfma_f32_32x32x16_bf16 v[48:63], a[8:11], a[12:15], v[48:63]
  ds_read_b64_tr_b16 a[40:41], v27 offset:26624
  ds_read_b64_tr_b16 a[42:43], v27 offset:27648
  ds_read_b128 a[44:47], v26 offset:41984
  s_waitcnt lgkmcnt(9)
  v_mfma_f32_32x32x16_bf16 v[48:63], a[16:19], a[20:23], v[48:63]
  ds_read_b64_tr_b16 a[48:49], v27 offset:28672
  ds_read_b64_tr_b16 a[50:51], v27 offset:29696
  ds_read_b128 a[52:55], v26 offset:43008
  s_waitcnt lgkmcnt(9)
  v_mfma_f32_32x32x16_bf16 v[48:63], a[24:27], a[28:31], v[48:63]
  ds_read_b64_tr_b16 a[56:57], v27 offset:30720
  ds_read_b64_tr_b16 a[58:59], v27 offset:31744
  ds_read_b128 a[60:63], v26 offset:44032
  s_waitcnt lgkmcnt(9)
  v_mfma_f32_32x32x16_bf16 v[48:63], a[32:35], a[36:39], v[48:63]
  s_waitcnt lgkmcnt(6)
  v_mfma_f32_32x32x16_bf16 v[48:63], a[40:43], a[44:47], v[48:63]
  s_waitcnt lgkmcnt(0)
  s_barrier
  ds_read_b64_tr_b16 a[0:1], v27 offset:0
  ds_read_b64_tr_b16 a[2:3], v27 offset:1024
  ds_read_b128 a[4:7], v26 offset:0
  ds_read_b64_tr_b16 a[8:9], v27 offset:2048
  ds_read_b64_tr_b16 a[10:11], v27 offset:3072
  ds_read_b128 a[12:15], v26 offset:1024
  v_mfma_f32_32x32x16_bf16 v[48:63], a[48:51], a[52:55], v[48:63]
  ds_read_b64_tr_b16 a[16:17], v27 offset:4096
  ds_read_b64_tr_b16 a[18:19], v27 offset:5120
  ds_read_b128 a[20:23], v26 offset:2048
  v_mfma_f32_32x32x16_bf16 v[48:63], a[56:59], a[60:63], v[48:63]
  ds_read_b64_tr_b16 a[24:25], v27 offset:6144
  ds_read_b64_tr_b16 a[26:27], v27 offset:7168
  ds_read_b128 a[28:31], v26 offset:3072
  s_waitcnt lgkmcnt(9)
  v_mfma_f32_32x32x16_bf16 v[48:63], a[0:3], a[4:7], v[48:63]
  ds_read_b64_tr_b16 a[32:33], v27 offset:8192
  ds_read_b64_tr_b16 a[34:35], v27 offset:9216
  ds_read_b128 a[36:39], v26 offset:8192
  s_waitcnt lgkmcnt(9)
  v_mfma_f32_32x32x16_bf16 v[48:63], a[8:11], a[12:15], v[48:63]
  ds_read_b64_tr_b16 a[40:41], v27 offset:10240
  ds_read_b64_tr_b16 a[42:43], v27 offset:11264
  ds_read_b128 a[44:47], v26 offset:9216
  s_waitcnt lgkmcnt(9)
  v_mfma_f32_32x32x16_bf16 v[48:63], a[16:19], a[20:23], v[48:63]
  ds_read_b64_tr_b16 a[48:49], v27 offset:12288
  ds_read_b64_tr_b16 a[50:51], v27 offset:13312
  ds_read_b128 a[52:55], v26 offset:10240
  s_waitcnt lgkmcnt(9)
  v_mfma_f32_32x32x16_bf16 v[48:63], a[24:27], a[28:31], v[48:63]
  ds_read_b64_tr_b16 a[56:57], v27 offset:14336
  ds_read_b64_tr_b16 a[58:59], v27 offset:15360
  ds_read_b128 a[60:63], v26 offset:11264
  s_waitcnt lgkmcnt(9)
  v_mfma_f32_32x32x16_bf16 v[48:63], a[32:35], a[36:39], v[48:63]
  s_waitcnt lgkmcnt(6)
  v_mfma_f32_32x32x16_bf16 v[48:63], a[40:43], a[44:47], v[48:63]
  s_waitcnt lgkmcnt(0)
  s_barrier
  ds_read_b64_tr_b16 a[0:1], v28 offset:0
  ds_read_b64_tr_b16 a[2:3], v28 offset:1024
  ds_read_b128 a[4:7], v26 offset:16384
  ds_read_b64_tr_b16 a[8:9], v28 offset:2048
  ds_read_b64_tr_b16 a[10:11], v28 offset:3072
  ds_read_b128 a[12:15], v26 offset:17408
  v_mfma_f32_32x32x16_bf16 v[48:63], a[48:51], a[52:55], v[48:63]
  ds_read_b64_tr_b16 a[16:17], v28 offset:4096
  ds_read_b64_tr_b16 a[18:19], v28 offset:5120
  ds_read_b128 a[20:23], v26 offset:18432
  v_mfma_f32_32x32x16_bf16 v[48:63], a[56:59], a[60:63], v[48:63]
  ds_read_b64_tr_b16 a[24:25], v28 offset:6144
  ds_read_b64_tr_b16 a[26:27], v28 offset:7168
  ds_read_b128 a[28:31], v26 offset:19456
  s_waitcnt lgkmcnt(9)
  v_mfma_f32_32x32x16_bf16 v[48:63], a[0:3], a[4:7], v[48:63]
  ds_read_b64_tr_b16 a[32:33], v28 offset:8192
  ds_read_b64_tr_b16 a[34:35], v28 offset:9216
  ds_read_b128 a[36:39], v26 offset:24576
  s_waitcnt lgkmcnt(9)
  v_mfma_f32_32x32x16_bf16 v[48:63], a[8:11], a[12:15], v[48:63]
  ds_read_b64_tr_b16 a[40:41], v28 offset:10240
  ds_read_b64_tr_b16 a[42:43], v28 offset:11264
  ds_read_b128 a[44:47], v26 offset:25600
  s_waitcnt lgkmcnt(9)
  v_mfma_f32_32x32x16_bf16 v[48:63], a[16:19], a[20:23], v[48:63]
  ds_read_b64_tr_b16 a[48:49], v28 offset:12288
  ds_read_b64_tr_b16 a[50:51], v28 offset:13312
  ds_read_b128 a[52:55], v26 offset:26624
  s_waitcnt lgkmcnt(9)
  v_mfma_f32_32x32x16_bf16 v[48:63], a[24:27], a[28:31], v[48:63]
  ds_read_b64_tr_b16 a[56:57], v28 offset:14336
  ds_read_b64_tr_b16 a[58:59], v28 offset:15360
  ds_read_b128 a[60:63], v26 offset:27648
  s_waitcnt lgkmcnt(9)
  v_mfma_f32_32x32x16_bf16 v[48:63], a[32:35], a[36:39], v[48:63]
  s_waitcnt lgkmcnt(6)
  v_mfma_f32_32x32x16_bf16 v[48:63], a[40:43], a[44:47], v[48:63]
  s_waitcnt lgkmcnt(0)
  s_barrier
  s_cmp_lg_u32 s52, 0
  s_cbranch_scc1 L_skip_56
  buffer_load_dwordx2 v[16:17], v13, s[44:47], s83 offen offset:256 sc1
L_skip_56:
  ds_read_b64_tr_b16 a[0:1], v27 offset:32768
  ds_read_b64_tr_b16 a[2:3], v27 offset:33792
  ds_read_b128 a[4:7], v26 offset:32768
  ds_read_b64_tr_b16 a[8:9], v27 offset:34816
  ds_read_b64_tr_b16 a[10:11], v27 offset:35840
  ds_read_b128 a[12:15], v26 offset:33792
  v_mfma_f32_32x32x16_bf16 v[48:63], a[48:51], a[52:55], v[48:63]
  ds_read_b64_tr_b16 a[16:17], v27 offset:36864
  ds_read_b64_tr_b16 a[18:19], v27 offset:37888
  ds_read_b128 a[20:23], v26 offset:34816
  v_mfma_f32_32x32x16_bf16 v[48:63], a[56:59], a[60:63], v[48:63]
  ds_read_b64_tr_b16 a[24:25], v27 offset:38912
  ds_read_b64_tr_b16 a[26:27], v27 offset:39936
  ds_read_b128 a[28:31], v26 offset:35840
  s_waitcnt lgkmcnt(9)
  v_mfma_f32_32x32x16_bf16 v[48:63], a[0:3], a[4:7], v[48:63]
  ds_read_b64_tr_b16 a[32:33], v27 offset:40960
  ds_read_b64_tr_b16 a[34:35], v27 offset:41984
  ds_read_b128 a[36:39], v26 offset:40960
  s_waitcnt lgkmcnt(9)
  v_mfma_f32_32x32x16_bf16 v[48:63], a[8:11], a[12:15], v[48:63]
  ds_read_b64_tr_b16 a[40:41], v27 offset:43008
  ds_read_b64_tr_b16 a[42:43], v27 offset:44032
  ds_read_b128 a[44:47], v26 offset:41984
  s_waitcnt lgkmcnt(9)
  v_mfma_f32_32x32x16_bf16 v[48:63], a[16:19], a[20:23], v[48:63]
  ds_read_b64_tr_b16 a[48:49], v27 offset:45056
  ds_read_b64_tr_b16 a[50:51], v27 offset:46080
  ds_read_b128 a[52:55], v26 offset:43008
  s_waitcnt lgkmcnt(9)
  v_mfma_f32_32x32x16_bf16 v[48:63], a[24:27], a[28:31], v[48:63]
  ds_read_b64_tr_b16 a[56:57], v27 offset:47104
  ds_read_b64_tr_b16 a[58:59], v27 offset:48128
  ds_read_b128 a[60:63], v26 offset:44032
  s_waitcnt lgkmcnt(9)
  v_mfma_f32_32x32x16_bf16 v[48:63], a[32:35], a[36:39], v[48:63]
  s_waitcnt lgkmcnt(6)
  v_mfma_f32_32x32x16_bf16 v[48:63], a[40:43], a[44:47], v[48:63]
  s_cmp_lg_u32 s52, 0
  s_cbranch_scc1 L_skip_57
  s_waitcnt vmcnt(0)
  s_mov_b32 s84, 65536
  s_branch L_pchk_60
L_poll_58:
  s_sleep 1
  buffer_load_dwordx2 v[16:17], v13, s[44:47], s83 offen offset:256 sc1
  s_waitcnt vmcnt(0)
L_pchk_60:
  v_cmp_eq_u64 vcc, s[60:61], v[16:17]
  s_and_b32 s64, vcc_lo, 255
  s_cmp_eq_u32 s64, 255
  s_cbranch_scc1 L_pok_59
  s_sub_u32 s84, s84, 1
  s_cmp_lg_u32 s84, 0
  s_cbranch_scc1 L_poll_58
L_pok_59:
L_skip_57:
  s_waitcnt lgkmcnt(0)
  s_barrier
  ds_read_b64_tr_b16 a[0:1], v28 offset:32768
  ds_read_b64_tr_b16 a[2:3], v28 offset:33792
  ds_read_b128 a[4:7], v26 offset:0
  ds_read_b64_tr_b16 a[8:9], v28 offset:34816
  ds_read_b64_tr_b16 a[10:11], v28 offset:35840
  ds_read_b128 a[12:15], v26 offset:1024
  v_mfma_f32_32x32x16_bf16 v[48:63], a[48:51], a[52:55], v[48:63]
  ds_read_b64_tr_b16 a[16:17], v28 offset:36864
  ds_read_b64_tr_b16 a[18:19], v28 offset:37888
  ds_read_b128 a[20:23], v26 offset:2048
  v_mfma_f32_32x32x16_bf16 v[48:63], a[56:59], a[60:63], v[48:63]
  ds_read_b64_tr_b16 a[24:25], v28 offset:38912
  ds_read_b64_tr_b16 a[26:27], v28 offset:39936
  ds_read_b128 a[28:31], v26 offset:3072
  s_waitcnt lgkmcnt(9)
  v_mfma_f32_32x32x16_bf16 v[48:63], a[0:3], a[4:7], v[48:63]
  ds_read_b64_tr_b16 a[32:33], v28 offset:40960
  ds_read_b64_tr_b16 a[34:35], v28 offset:41984
  ds_read_b128 a[36:39], v26 offset:8192
  s_waitcnt lgkmcnt(9)
  v_mfma_f32_32x32x16_bf16 v[48:63], a[8:11], a[12:15], v[48:63]
  ds_read_b64_tr_b16 a[40:41], v28 offset:43008
  ds_read_b64_tr_b16 a[42:43], v28 offset:44032
  ds_read_b128 a[44:47], v26 offset:9216
  s_waitcnt lgkmcnt(9)
  v_mfma_f32_32x32x16_bf16 v[48:63], a[16:19], a[20:23], v[48:63]
  ds_read_b64_tr_b16 a[48:49], v28 offset:45056
  ds_read_b64_tr_b16 a[50:51], v28 offset:46080
  ds_read_b128 a[52:55], v26 offset:10240
  s_waitcnt lgkmcnt(9)
  v_mfma_f32_32x32x16_bf16 v[48:63], a[24:27], a[28:31], v[48:63]
  ds_read_b64_tr_b16 a[56:57], v28 offset:47104
  ds_read_b64_tr_b16 a[58:59], v28 offset:48128
  ds_read_b128 a[60:63], v26 offset:11264
  s_waitcnt lgkmcnt(9)
  v_mfma_f32_32x32x16_bf16 v[48:63], a[32:35], a[36:39], v[48:63]
  s_waitcnt lgkmcnt(6)
  v_mfma_f32_32x32x16_bf16 v[48:63], a[40:43], a[44:47], v[48:63]
  s_waitcnt lgkmcnt(0)
  s_barrier
  ds_read_b64_tr_b16 a[0:1], v28 offset:16384
  ds_read_b64_tr_b16 a[2:3], v28 offset:17408
  ds_read_b128 a[4:7], v26 offset:16384
  ds_read_b64_tr_b16 a[8:9], v28 offset:18432
  ds_read_b64_tr_b16 a[10:11], v28 offset:19456
  ds_read_b128 a[12:15], v26 offset:17408
  v_mfma_f32_32x32x16_bf16 v[48:63], a[48:51], a[52:55], v[48:63]
  ds_read_b64_tr_b16 a[16:17], v28 offset:20480
  ds_read_b64_tr_b16 a[18:19], v28 offset:21504
  ds_read_b128 a[20:23], v26 offset:18432
  v_mfma_f32_32x32x16_bf16 v[48:63], a[56:59], a[60:63], v[48:63]
  ds_read_b64_tr_b16 a[24:25], v28 offset:22528
  ds_read_b64_tr_b16 a[26:27], v28 offset:23552
  ds_read_b128 a[28:31], v26 offset:19456
  s_waitcnt lgkmcnt(9)
  v_mfma_f32_32x32x16_bf16 v[48:63], a[0:3], a[4:7], v[48:63]
  ds_read_b64_tr_b16 a[32:33], v28 offset:24576
  ds_read_b64_tr_b16 a[34:35], v28 offset:25600
  ds_read_b128 a[36:39], v26 offset:24576
  buffer_load_dword v30, v30, s[44:47], 0 offen sc1
  s_waitcnt lgkmcnt(9)
  v_mfma_f32_32x32x16_bf16 v[48:63], a[8:11], a[12:15], v[48:63]
  ds_read_b64_tr_b16 a[40:41], v28 offset:26624
  ds_read_b64_tr_b16 a[42:43], v28 offset:27648
  ds_read_b128 a[44:47], v26 offset:25600
  s_waitcnt lgkmcnt(9)
  v_mfma_f32_32x32x16_bf16 v[48:63], a[16:19], a[20:23], v[48:63]
  ds_read_b64_tr_b16 a[48:49], v28 offset:28672
  ds_read_b64_tr_b16 a[50:51], v28 offset:29696
  ds_read_b128 a[52:55], v26 offset:26624
  s_waitcnt lgkmcnt(9)
  v_mfma_f32_32x32x16_bf16 v[48:63], a[24:27], a[28:31], v[48:63]
  ds_read_b64_tr_b16 a[56:57], v28 offset:30720
  ds_read_b64_tr_b16 a[58:59], v28 offset:31744
  ds_read_b128 a[60:63], v26 offset:27648
  s_waitcnt lgkmcnt(9)
  v_mfma_f32_32x32x16_bf16 v[48:63], a[32:35], a[36:39], v[48:63]
  s_waitcnt lgkmcnt(6)
  v_mfma_f32_32x32x16_bf16 v[48:63], a[40:43], a[44:47], v[48:63]
  s_waitcnt lgkmcnt(0)
  s_barrier
  ds_read_b64_tr_b16 a[0:1], v27 offset:16384
  ds_read_b64_tr_b16 a[2:3], v27 offset:17408
  ds_read_b128 a[4:7], v26 offset:32768
  ds_read_b64_tr_b16 a[8:9], v27 offset:18432
  ds_read_b64_tr_b16 a[10:11], v27 offset:19456
  ds_read_b128 a[12:15], v26 offset:33792
  v_mfma_f32_32x32x16_bf16 v[48:63], a[48:51], a[52:55], v[48:63]
  ds_read_b64_tr_b16 a[16:17], v27 offset:20480
  ds_read_b64_tr_b16 a[18:19], v27 offset:21504
  ds_read_b128 a[20:23], v26 offset:34816
  v_mfma_f32_32x32x16_bf16 v[48:63], a[56:59], a[60:63], v[48:63]
  ds_read_b64_tr_b16 a[24:25], v27 offset:22528
  ds_read_b64_tr_b16 a[26:27], v27 offset:23552
  ds_read_b128 a[28:31], v26 offset:35840
  s_waitcnt lgkmcnt(9)
  v_mfma_f32_32x32x16_bf16 v[32:47], a[0:3], a[4:7], 0
  ds_read_b64_tr_b16 a[32:33], v27 offset:24576
  ds_read_b64_tr_b16 a[34:35], v27 offset:25600
  ds_read_b128 a[36:39], v26 offset:40960
  s_waitcnt lgkmcnt(9)
  v_mfma_f32_32x32x16_bf16 v[32:47], a[8:11], a[12:15], v[32:47]
  ds_read_b64_tr_b16 a[40:41], v27 offset:26624
  ds_read_b64_tr_b16 a[42:43], v27 offset:27648
  ds_read_b128 a[44:47], v26 offset:41984
  s_waitcnt lgkmcnt(9)
  v_mfma_f32_32x32x16_bf16 v[32:47], a[16:19], a[20:23], v[32:47]
  ds_read_b64_tr_b16 a[48:49], v27 offset:28672
  ds_read_b64_tr_b16 a[50:51], v27 offset:29696
  ds_read_b128 a[52:55], v26 offset:43008
  s_waitcnt lgkmcnt(9)
  v_mfma_f32_32x32x16_bf16 v[32:47], a[24:27], a[28:31], v[32:47]
  ds_read_b64_tr_b16 a[56:57], v27 offset:30720
  ds_read_b64_tr_b16 a[58:59], v27 offset:31744
  ds_read_b128 a[60:63], v26 offset:44032
  s_waitcnt lgkmcnt(9)
  v_mfma_f32_32x32x16_bf16 v[32:47], a[32:35], a[36:39], v[32:47]
  s_waitcnt lgkmcnt(6)
  v_mfma_f32_32x32x16_bf16 v[32:47], a[40:43], a[44:47], v[32:47]
  s_waitcnt lgkmcnt(0)
  s_barrier
  ds_read_b64_tr_b16 a[0:1], v27 offset:0
  ds_read_b64_tr_b16 a[2:3], v27 offset:1024
  ds_read_b128 a[4:7], v26 offset:0
  ds_read_b64_tr_b16 a[8:9], v27 offset:2048
  ds_read_b64_tr_b16 a[10:11], v27 offset:3072
  ds_read_b128 a[12:15], v26 offset:1024
  v_mfma_f32_32x32x16_bf16 v[32:47], a[48:51], a[52:55], v[32:47]
  ds_read_b64_tr_b16 a[16:17], v27 offset:4096
  ds_read_b64_tr_b16 a[18:19], v27 offset:5120
  ds_read_b128 a[20:23], v26 offset:2048
  v_mfma_f32_32x32x16_bf16 v[32:47], a[56:59], a[60:63], v[32:47]
  ds_read_b64_tr_b16 a[24:25], v27 offset:6144
  ds_read_b64_tr_b16 a[26:27], v27 offset:7168
  ds_read_b128 a[28:31], v26 offset:3072
  s_waitcnt lgkmcnt(9)
  v_mfma_f32_32x32x16_bf16 v[32:47], a[0:3], a[4:7], v[32:47]
  ds_read_b64_tr_b16 a[32:33], v27 offset:8192
  ds_read_b64_tr_b16 a[34:35], v27 offset:9216
  ds_read_b128 a[36:39], v26 offset:8192
  s_waitcnt lgkmcnt(9)
  v_mfma_f32_32x32x16_bf16 v[32:47], a[8:11], a[12:15], v[32:47]
  ds_read_b64_tr_b16 a[40:41], v27 offset:10240
  ds_read_b64_tr_b16 a[42:43], v27 offset:11264
  ds_read_b128 a[44:47], v26 offset:9216
  s_waitcnt lgkmcnt(9)
  v_mfma_f32_32x32x16_bf16 v[32:47], a[16:19], a[20:23], v[32:47]
  ds_read_b64_tr_b16 a[48:49], v27 offset:12288
  ds_read_b64_tr_b16 a[50:51], v27 offset:13312
  ds_read_b128 a[52:55], v26 offset:10240
  s_waitcnt lgkmcnt(9)
  v_mfma_f32_32x32x16_bf16 v[32:47], a[24:27], a[28:31], v[32:47]
  ds_read_b64_tr_b16 a[56:57], v27 offset:14336
  ds_read_b64_tr_b16 a[58:59], v27 offset:15360
  ds_read_b128 a[60:63], v26 offset:11264
  s_waitcnt lgkmcnt(9)
  v_mfma_f32_32x32x16_bf16 v[32:47], a[32:35], a[36:39], v[32:47]
  s_waitcnt lgkmcnt(6)
  v_mfma_f32_32x32x16_bf16 v[32:47], a[40:43], a[44:47], v[32:47]
  s_waitcnt lgkmcnt(0)
  s_barrier
  ds_read_b64_tr_b16 a[0:1], v28 offset:0
  ds_read_b64_tr_b16 a[2:3], v28 offset:1024
  ds_read_b128 a[4:7], v26 offset:16384
  ds_read_b64_tr_b16 a[8:9], v28 offset:2048
  ds_read_b64_tr_b16 a[10:11], v28 offset:3072
  ds_read_b128 a[12:15], v26 offset:17408
  v_mfma_f32_32x32x16_bf16 v[32:47], a[48:51], a[52:55], v[32:47]
  ds_read_b64_tr_b16 a[16:17], v28 offset:4096
  ds_read_b64_tr_b16 a[18:19], v28 offset:5120
  ds_read_b128 a[20:23], v26 offset:18432
  v_mfma_f32_32x32x16_bf16 v[32:47], a[56:59], a[60:63], v[32:47]
  ds_read_b64_tr_b16 a[24:25], v28 offset:6144
  ds_read_b64_tr_b16 a[26:27], v28 offset:7168
  ds_read_b128 a[28:31], v26 offset:19456
  s_waitcnt lgkmcnt(9)
  v_mfma_f32_32x32x16_bf16 v[32:47], a[0:3], a[4:7], v[32:47]
  ds_read_b64_tr_b16 a[32:33], v28 offset:8192
  ds_read_b64_tr_b16 a[34:35], v28 offset:9216
  ds_read_b128 a[36:39], v26 offset:24576
  s_waitcnt lgkmcnt(9)
  v_mfma_f32_32x32x16_bf16 v[32:47], a[8:11], a[12:15], v[32:47]
  ds_read_b64_tr_b16 a[40:41], v28 offset:10240
  ds_read_b64_tr_b16 a[42:43], v28 offset:11264
  ds_read_b128 a[44:47], v26 offset:25600
  s_waitcnt lgkmcnt(9)
  v_mfma_f32_32x32x16_bf16 v[32:47], a[16:19], a[20:23], v[32:47]
  ds_read_b64_tr_b16 a[48:49], v28 offset:12288
  ds_read_b64_tr_b16 a[50:51], v28 offset:13312
  ds_read_b128 a[52:55], v26 offset:26624
  s_waitcnt lgkmcnt(9)
  v_mfma_f32_32x32x16_bf16 v[32:47], a[24:27], a[28:31], v[32:47]
  ds_read_b64_tr_b16 a[56:57], v28 offset:14336
  ds_read_b64_tr_b16 a[58:59], v28 offset:15360
  ds_read_b128 a[60:63], v26 offset:27648
  s_waitcnt lgkmcnt(9)
  v_mfma_f32_32x32x16_bf16 v[32:47], a[32:35], a[36:39], v[32:47]
  s_waitcnt lgkmcnt(6)
  v_mfma_f32_32x32x16_bf16 v[32:47], a[40:43], a[44:47], v[32:47]
  s_waitcnt lgkmcnt(0)
  s_barrier
  ds_read_b64_tr_b16 a[0:1], v27 offset:32768
  ds_read_b64_tr_b16 a[2:3], v27 offset:33792
  ds_read_b128 a[4:7], v26 offset:32768
  ds_read_b64_tr_b16 a[8:9], v27 offset:34816
  ds_read_b64_tr_b16 a[10:11], v27 offset:35840
  ds_read_b128 a[12:15], v26 offset:33792
  v_mfma_f32_32x32x16_bf16 v[32:47], a[48:51], a[52:55], v[32:47]
  ds_read_b64_tr_b16 a[16:17], v27 offset:36864
  ds_read_b64_tr_b16 a[18:19], v27 offset:37888
  ds_read_b128 a[20:23], v26 offset:34816
  v_mfma_f32_32x32x16_bf16 v[32:47], a[56:59], a[60:63], v[32:47]
  ds_read_b64_tr_b16 a[24:25], v27 offset:38912
  ds_read_b64_tr_b16 a[26:27], v27 offset:39936
  ds_read_b128 a[28:31], v26 offset:35840
  s_waitcnt lgkmcnt(9)
  v_mfma_f32_32x32x16_bf16 v[32:47], a[0:3], a[4:7], v[32:47]
  ds_read_b64_tr_b16 a[32:33], v27 offset:40960
  ds_read_b64_tr_b16 a[34:35], v27 offset:41984
  ds_read_b128 a[36:39], v26 offset:40960
  s_waitcnt lgkmcnt(9)
  v_mfma_f32_32x32x16_bf16 v[32:47], a[8:11], a[12:15], v[32:47]
  ds_read_b64_tr_b16 a[40:41], v27 offset:43008
  ds_read_b64_tr_b16 a[42:43], v27 offset:44032
  ds_read_b128 a[44:47], v26 offset:41984
  s_waitcnt lgkmcnt(9)
  v_mfma_f32_32x32x16_bf16 v[32:47], a[16:19], a[20:23], v[32:47]
  ds_read_b64_tr_b16 a[48:49], v27 offset:45056
  ds_read_b64_tr_b16 a[50:51], v27 offset:46080
  ds_read_b128 a[52:55], v26 offset:43008
  s_waitcnt lgkmcnt(9)
  v_mfma_f32_32x32x16_bf16 v[32:47], a[24:27], a[28:31], v[32:47]
  ds_read_b64_tr_b16 a[56:57], v27 offset:47104
  ds_read_b64_tr_b16 a[58:59], v27 offset:48128
  ds_read_b128 a[60:63], v26 offset:44032
  s_waitcnt lgkmcnt(9)
  v_mfma_f32_32x32x16_bf16 v[32:47], a[32:35], a[36:39], v[32:47]
  s_waitcnt lgkmcnt(6)
  v_mfma_f32_32x32x16_bf16 v[32:47], a[40:43], a[44:47], v[32:47]
  s_waitcnt lgkmcnt(3)
  v_mfma_f32_32x32x16_bf16 v[32:47], a[48:51], a[52:55], v[32:47]
  s_waitcnt lgkmcnt(0)
  v_mfma_f32_32x32x16_bf16 v[32:47], a[56:59], a[60:63], v[32:47]
  s_waitcnt vmcnt(0)
  s_nop 7
  s_nop 4
  v_sub_f32 v32, v32, v48
  v_sub_f32 v33, v33, v49
  v_sub_f32 v34, v34, v50
  v_sub_f32 v35, v35, v51
  v_sub_f32 v36, v36, v52
  v_sub_f32 v37, v37, v53
  v_sub_f32 v38, v38, v54
  v_sub_f32 v39, v39, v55
  v_sub_f32 v40, v40, v56
  v_sub_f32 v41, v41, v57
  v_sub_f32 v42, v42, v58
  v_sub_f32 v43, v43, v59
  v_sub_f32 v44, v44, v60
  v_sub_f32 v45, v45, v61
  v_sub_f32 v46, v46, v62
  v_sub_f32 v47, v47, v63
  v_fma_f32 v32, v32, v30, v48
  v_fma_f32 v33, v33, v30, v49
  v_fma_f32 v34, v34, v30, v50
  v_fma_f32 v35, v35, v30, v51
  v_fma_f32 v36, v36, v30, v52
  v_fma_f32 v37, v37, v30, v53
  v_fma_f32 v38, v38, v30, v54
  v_fma_f32 v39, v39, v30, v55
  v_fma_f32 v40, v40, v30, v56
  v_fma_f32 v41, v41, v30, v57
  v_fma_f32 v42, v42, v30, v58
  v_fma_f32 v43, v43, v30, v59
  v_fma_f32 v44, v44, v30, v60
  v_fma_f32 v45, v45, v30, v61
  v_fma_f32 v46, v46, v30, v62
  v_fma_f32 v47, v47, v30, v63
  v_cvt_pk_bf16_f32 v96, v32, v33
  v_cvt_pk_bf16_f32 v97, v34, v35
  v_cvt_pk_bf16_f32 v98, v36, v37
  v_cvt_pk_bf16_f32 v99, v38, v39
  v_cvt_pk_bf16_f32 v100, v40, v41
  v_cvt_pk_bf16_f32 v101, v42, v43
  v_cvt_pk_bf16_f32 v102, v44, v45
  v_cvt_pk_bf16_f32 v103, v46, v47
  s_nop 1
  v_permlane32_swap_b32 v96, v98
  v_permlane32_swap_b32 v97, v99
  v_permlane32_swap_b32 v100, v102
  v_permlane32_swap_b32 v101, v103
  s_nop 1
  buffer_store_dwordx4 v[96:99], v29, s[48:51], s90 offen offset:0
  buffer_store_dwordx4 v[100:103], v29, s[48:51], s90 offen offset:32
L_fin:
L_end:
  s_endpgm
.section .rodata,"a"
.p2align 6
.amdhsa_kernel gated_mix__linear_attn_block__dense_activation_mish__prompt_kernel
  .amdhsa_next_free_vgpr 256
  .amdhsa_next_free_sgpr 102
  .amdhsa_accum_offset 144
  .amdhsa_group_segment_fixed_size 0
  .amdhsa_kernarg_size 88
  .amdhsa_user_sgpr_count 2
  .amdhsa_user_sgpr_kernarg_segment_ptr 1
  .amdhsa_system_sgpr_workgroup_id_x 1
.end_amdhsa_kernel
```
